```python
import torch

def _softmax(x, axis=-1):
    return torch.softmax(x, dim=axis)
def _gelu(x):
    return torch.nn.functional.gelu(x, approximate="tanh")
def _silu(x):
    return torch.nn.functional.silu(x)
def _sigmoid(x):
    return torch.sigmoid(x)
def _layernorm(x, axis=-1, eps=1e-5):
    m = x.mean(dim=axis, keepdim=True)
    v = x.var(dim=axis, keepdim=True, unbiased=False)
    return (x - m) / torch.sqrt(v + eps)
def _scatter_add(tgt, idx, src, axis=0):
    return tgt.clone().index_add_(axis, idx, src)
def _segment_sum(src, seg, n):
    out = torch.zeros((n,) + src.shape[1:], dtype=src.dtype)
    return out.index_add_(0, seg, src)
def _pad(x, pw):
    flat = tuple(v for pair in reversed(pw) for v in pair)
    return torch.nn.functional.pad(x, flat)

kernel_name = 'parallel_sum__mha_block_cached__dense_activation_gelu__decode'

def setup_inputs():

    _w = (lambda a: (lambda t: t.to(torch.bfloat16) if t.is_floating_point() else t)(torch.as_tensor(a)))
    def _A_setup():
        B, Sq, D = 1, 1, 576
        H, Sk, Dh = 32, 32768, 128
        return {
            "x": _w((lambda *s: torch.randn(*s, dtype=torch.bfloat16) * 0.05)(B, Sq, D)),
            "k_cache": _w((lambda *s: torch.randn(*s, dtype=torch.bfloat16) * 3.2)(B, H, Sk, Dh)),
            "v_cache": _w((lambda *s: torch.randn(*s, dtype=torch.bfloat16) * 0.8)(B, H, Sk, Dh)),
            "wq": _w((lambda *s: torch.randn(*s, dtype=torch.bfloat16) * 3.2)(D, H * Dh) * (D ** -0.5)),
            "wo": _w((lambda *s: torch.randn(*s, dtype=torch.bfloat16) * 0.8)(H * Dh, D) * ((H * Dh) ** -0.5)),
        }
    _A_in = _A_setup()

    def _B_setup():
        B, S, D, F = 1, 1, 576, 4608
        return {
            "x": _w((lambda *s: torch.randn(*s, dtype=torch.bfloat16) * 0.05)(B, S, D)),
            "w1": _w((lambda *s: torch.randn(*s, dtype=torch.bfloat16) * 3.2)(D, F) * (D ** -0.5)),
            "b1": _w((lambda *s: torch.randn(*s, dtype=torch.bfloat16) * 3.2)(F) * 0.01),
            "w2": _w((lambda *s: torch.randn(*s, dtype=torch.bfloat16) * 0.4)(F, D) * (F ** -0.5)),
            "b2": _w((lambda *s: torch.randn(*s, dtype=torch.bfloat16) * 0.4)(D) * 0.01),
        }
    _B_in = _B_setup()

    return {
        "A_x": _A_in["x"],
        "A_k_cache": _A_in["k_cache"],
        "A_v_cache": _A_in["v_cache"],
        "A_wq": _A_in["wq"],
        "A_wo": _A_in["wo"],
        "B_x": _B_in["x"],
        "B_w1": _B_in["w1"],
        "B_b1": _B_in["b1"],
        "B_w2": _B_in["w2"],
        "B_b2": _B_in["b2"],
    }

def reference(A_x, A_k_cache, A_v_cache, A_wq, A_wo, B_x, B_w1, B_b1, B_w2, B_b2):
    def _A_ref(x, k_cache, v_cache, wq, wo):
        B, Sq, D = x.shape
        H, Dh = 32, 128
        q = (lambda x, *d: x.permute(*d))((x @ wq).reshape(B, Sq, H, Dh), 0, 2, 1, 3)
        scores = torch.einsum("bhqd,bhkd->bhqk", q, k_cache) * (Dh ** -0.5)
        p = _softmax(scores, axis=-1)
        o = torch.einsum("bhqk,bhkd->bhqd", p, v_cache)
        return (lambda x, *d: x.permute(*d))(o, 0, 2, 1, 3).reshape(B, Sq, H * Dh) @ wo

    def _B_ref(x, w1, b1, w2, b2):
        h = torch.einsum("bsd,df->bsf", x, w1) + b1
        h = _gelu(h)
        return torch.einsum("bsf,fd->bsd", h, w2) + b2

    x = A_x
    xn = _layernorm(x, axis=-1)
    return x + _A_ref(xn, A_k_cache, A_v_cache, A_wq, A_wo) + _B_ref(xn, B_w1, B_b1, B_w2, B_b2)
```

```asm
; @launch grid=(256,1,1) block=(320,1,1) lds=86016
.amdgcn_target "amdgcn-amd-amdhsa--gfx950"
.text
.globl parallel_sum__mha_block_cached__dense_activation_gelu__decode_kernel
.p2align 8
.type parallel_sum__mha_block_cached__dense_activation_gelu__decode_kernel,@function
parallel_sum__mha_block_cached__dense_activation_gelu__decode_kernel:
    s_cmp_ge_u32 s2, 256
    s_cbranch_scc1 L_exit
    s_load_dwordx16 s[4:19], s[0:1], 0
    s_load_dwordx8 s[20:27], s[0:1], 64
    s_load_dwordx2 s[28:29], s[0:1], 96
    v_lshrrev_b32 v1, 6, v0
    v_and_b32 v0, 63, v0
    v_readfirstlane_b32 s52, v1
    s_and_b32 s58, s2, 7
    s_lshl_b32 s58, s58, 5
    s_lshr_b32 s59, s2, 3
    s_add_u32 s55, s58, s59
    s_and_b32 s54, s55, 7
    s_lshr_b32 s53, s55, 3
    s_sub_u32 s68, s2, 128
    s_mov_b32 s78, 0
    s_cmp_eq_u32 s52, 4
    s_cbranch_scc1 L_helper
    v_lshlrev_b32 v1, 4, v0
    s_lshl_b32 s38, s53, 23
    s_lshl_b32 s58, s54, 2
    s_add_u32 s58, s58, s52
    s_lshl_b32 s74, s58, 12
    s_mul_i32 s73, s53, 262144
    s_and_b32 s73, s73, 0x7e0000
    s_or_b32 s36, s73, s74
    s_or_b32 s36, s36, s38
    s_mov_b32 s37, 0
    s_waitcnt lgkmcnt(0)
    s_mov_b32 s32, s6
    s_and_b32 s33, s7, 0xffff
    s_mov_b32 s34, 0x10000000
    s_mov_b32 s35, 0x20000
    s_and_b32 s9, s9, 0xffff
    buffer_load_dwordx4 v[32:35], v1, s[32:35], s36 offen offset:0 nt
    buffer_load_dwordx4 v[36:39], v1, s[32:35], s36 offen offset:1024 nt
    buffer_load_dwordx4 v[40:43], v1, s[32:35], s36 offen offset:2048 nt
    buffer_load_dwordx4 v[44:47], v1, s[32:35], s36 offen offset:3072 nt
    s_add_u32 s36, s36, 0x20000
    s_and_b32 s36, s36, 0x7fffff
    s_or_b32 s36, s36, s38
    s_add_u32 s37, s37, 1
    s_cmp_eq_u32 s37, 64
    s_cselect_b32 s32, s8, s32
    s_cselect_b32 s33, s9, s33
    s_load_dwordx2 s[30:31], s[28:29], 0
    s_barrier
    buffer_load_dwordx4 v[48:51], v1, s[32:35], s36 offen offset:0 nt
    buffer_load_dwordx4 v[52:55], v1, s[32:35], s36 offen offset:1024 nt
    buffer_load_dwordx4 v[56:59], v1, s[32:35], s36 offen offset:2048 nt
    s_mov_b32 s48, s28
    s_and_b32 s49, s29, 0xffff
    s_mov_b32 s50, 0x1a0000
    s_mov_b32 s51, 0x20000
    v_and_b32 v20, 1, v0
    v_lshlrev_b32 v20, 4, v20
    v_mov_b32 v21, 0xffff
    v_lshlrev_b32 v20, v20, v21
    v_bfe_u32 v21, v0, 1, 2
    v_cmp_eq_u32 vcc, 0, v21
    s_nop 1
    v_cndmask_b32 v2, 0, v20, vcc
    v_cmp_eq_u32 vcc, 1, v21
    s_nop 1
    v_cndmask_b32 v3, 0, v20, vcc
    v_cmp_eq_u32 vcc, 2, v21
    s_nop 1
    v_cndmask_b32 v4, 0, v20, vcc
    v_cmp_eq_u32 vcc, 3, v21
    s_nop 1
    v_cndmask_b32 v5, 0, v20, vcc
    s_mov_b32 s60, 0xaaaaaaaa
    s_mov_b32 s61, 0xaaaaaaaa
    s_mov_b32 s62, 0xcccccccc
    s_mov_b32 s63, 0xcccccccc
    s_mov_b32 s64, 0x3db504f3
    s_mov_b32 s65, 0x3fb8aa3b
    v_mov_b32 v10, 0xff800000
    s_lshl_b32 s58, s52, 11
    s_add_u32 s58, s58, 0
    v_lshl_add_u32 v11, v0, 1, s58
    v_mov_b32 v22, v11
    v_and_b32 v23, 15, v0
    v_lshlrev_b32 v23, 4, v23
    v_mov_b32 v245, 0
    v_mov_b32 v24, 0
    v_mov_b32 v25, 0
    v_mov_b32 v26, 0
    v_mov_b32 v27, 0
    v_bfrev_b32 v248, v0
    v_lshrrev_b32 v248, 28, v248
    v_sub_u32 v249, 15, v248
    v_add_u32 v248, 16, v249
    s_lshl_b32 s58, s52, 2
    v_mov_b32 v247, s58
    s_lshl_b32 s58, s52, 8
    v_lshl_add_u32 v244, v0, 2, s58
    v_mov_b32 v242, 0
    ds_write_b32 v244, v242 offset:14336
    v_bfe_u32 v243, v0, 1, 3
    v_lshlrev_b32 v243, 11, v243
    v_and_b32 v20, 1, v0
    v_lshl_add_u32 v243, v20, 5, v243
    v_and_b32 v20, 16, v0
    v_add_u32 v243, v243, v20
    v_and_b32 v182, 15, v0
    v_lshlrev_b32 v182, 6, v182
    v_lshrrev_b32 v183, 4, v0
    v_lshl_add_u32 v182, v183, 4, v182
    s_lshl_b32 s79, s55, 11
    s_add_u32 s79, s79, 0x100000
    v_bfe_u32 v183, v0, 1, 3
    v_lshlrev_b32 v183, 14, v183
    v_and_b32 v184, 1, v0
    v_lshl_add_u32 v183, v184, 5, v183
    v_and_b32 v184, 16, v0
    v_add_u32 v183, v183, v184
    s_lshl_b32 s75, s55, 6
    s_lshl_b32 s59, s52, 17
    s_add_u32 s75, s75, s59
    s_add_u32 s75, s75, 0x60000
    v_lshrrev_b32 v186, 4, v0
    v_and_b32 v187, 15, v0
    v_lshlrev_b32 v187, 4, v187
    v_mul_u32_u24 v185, 4608, v186
    v_add_u32 v185, v185, v187
    v_mul_u32_u24 v186, 5760, v186
    v_add_u32 v186, v186, v187
    s_lshl_b32 s59, s52, 8
    s_mul_i32 s93, s55, 18432
    s_add_u32 s93, s93, s59
    s_mul_i32 s94, s55, 20736
    s_add_u32 s94, s94, s59
    s_add_u32 s95, s94, 4608
    s_mov_b32 s40, s20
    s_and_b32 s41, s21, 0xffff
    s_mov_b32 s42, 0x510000
    s_mov_b32 s43, 0x20000
    s_mov_b32 s44, s12
    s_and_b32 s45, s13, 0xffff
    s_mov_b32 s46, 0x480000
    s_mov_b32 s47, 0x20000
    s_lshl_b32 s59, s54, 2
    s_add_u32 s59, s59, s52
    s_lshl_b32 s59, s59, 6
    s_lshl_b32 s69, s53, 14
    s_add_u32 s69, s69, s59
    s_add_u32 s69, s69, 0x100000
    s_lshl_b32 s59, s52, 10
    v_lshl_add_u32 v238, v0, 4, s59
    s_lshl_b32 s59, s68, 14
    s_add_u32 s80, s59, 0x60000
    s_add_u32 s81, s80, 4096
    s_add_u32 s82, s80, 8192
    s_add_u32 s83, s80, 12288
    s_mov_b32 s57, 0
    s_waitcnt vmcnt(6)
    buffer_load_dwordx4 v[60:63], v1, s[32:35], s36 offen offset:3072 nt
    s_add_u32 s36, s36, 0x20000
    s_and_b32 s36, s36, 0x7fffff
    s_or_b32 s36, s36, s38
    s_add_u32 s37, s37, 1
    s_cmp_eq_u32 s37, 64
    s_cselect_b32 s32, s8, s32
    s_cselect_b32 s33, s9, s33
    s_waitcnt vmcnt(6)
    buffer_load_dwordx4 v[64:67], v1, s[32:35], s36 offen offset:0 nt
    s_waitcnt vmcnt(6)
    buffer_load_dwordx4 v[68:71], v1, s[32:35], s36 offen offset:1024 nt
    s_waitcnt vmcnt(6)
    buffer_load_dwordx4 v[72:75], v1, s[32:35], s36 offen offset:2048 nt
    s_waitcnt vmcnt(6)
    buffer_load_dwordx4 v[76:79], v1, s[32:35], s36 offen offset:3072 nt
    s_add_u32 s36, s36, 0x20000
    s_and_b32 s36, s36, 0x7fffff
    s_or_b32 s36, s36, s38
    s_add_u32 s37, s37, 1
    s_cmp_eq_u32 s37, 64
    s_cselect_b32 s32, s8, s32
    s_cselect_b32 s33, s9, s33
    s_waitcnt vmcnt(6)
    buffer_load_dwordx4 v[80:83], v1, s[32:35], s36 offen offset:0 nt
    s_waitcnt vmcnt(6)
    buffer_load_dwordx4 v[84:87], v1, s[32:35], s36 offen offset:1024 nt
    s_waitcnt vmcnt(6)
    buffer_load_dwordx4 v[88:91], v1, s[32:35], s36 offen offset:2048 nt
    s_waitcnt vmcnt(6)
    buffer_load_dwordx4 v[92:95], v1, s[32:35], s36 offen offset:3072 nt
    s_add_u32 s36, s36, 0x20000
    s_and_b32 s36, s36, 0x7fffff
    s_or_b32 s36, s36, s38
    s_add_u32 s37, s37, 1
    s_cmp_eq_u32 s37, 64
    s_cselect_b32 s32, s8, s32
    s_cselect_b32 s33, s9, s33
    s_waitcnt vmcnt(6)
    buffer_load_dwordx4 v[96:99], v1, s[32:35], s36 offen offset:0 nt
    s_waitcnt vmcnt(6)
    buffer_load_dwordx4 v[100:103], v1, s[32:35], s36 offen offset:1024 nt
    s_waitcnt vmcnt(6)
    buffer_load_dwordx4 v[104:107], v1, s[32:35], s36 offen offset:2048 nt
    s_waitcnt vmcnt(6)
    buffer_load_dwordx4 v[108:111], v1, s[32:35], s36 offen offset:3072 nt
    s_add_u32 s36, s36, 0x20000
    s_and_b32 s36, s36, 0x7fffff
    s_or_b32 s36, s36, s38
    s_add_u32 s37, s37, 1
    s_cmp_eq_u32 s37, 64
    s_cselect_b32 s32, s8, s32
    s_cselect_b32 s33, s9, s33
    s_waitcnt vmcnt(6)
    buffer_load_dwordx4 v[112:115], v1, s[32:35], s36 offen offset:0 nt
    s_waitcnt vmcnt(6)
    buffer_load_dwordx4 v[116:119], v1, s[32:35], s36 offen offset:1024 nt
    s_waitcnt vmcnt(6)
    buffer_load_dwordx4 v[120:123], v1, s[32:35], s36 offen offset:2048 nt
    s_waitcnt vmcnt(6)
    buffer_load_dwordx4 v[124:127], v1, s[32:35], s36 offen offset:3072 nt
    s_add_u32 s36, s36, 0x20000
    s_and_b32 s36, s36, 0x7fffff
    s_or_b32 s36, s36, s38
    s_add_u32 s37, s37, 1
    s_cmp_eq_u32 s37, 64
    s_cselect_b32 s32, s8, s32
    s_cselect_b32 s33, s9, s33
    s_waitcnt vmcnt(6)
    buffer_load_dwordx4 v[128:131], v1, s[32:35], s36 offen offset:0 nt
    s_waitcnt vmcnt(6)
    buffer_load_dwordx4 v[132:135], v1, s[32:35], s36 offen offset:1024 nt
    s_waitcnt vmcnt(6)
    buffer_load_dwordx4 v[136:139], v1, s[32:35], s36 offen offset:2048 nt
    s_waitcnt vmcnt(6)
    buffer_load_dwordx4 v[140:143], v1, s[32:35], s36 offen offset:3072 nt
    s_add_u32 s36, s36, 0x20000
    s_and_b32 s36, s36, 0x7fffff
    s_or_b32 s36, s36, s38
    s_add_u32 s37, s37, 1
    s_cmp_eq_u32 s37, 64
    s_cselect_b32 s32, s8, s32
    s_cselect_b32 s33, s9, s33
    s_waitcnt vmcnt(6)
    buffer_load_dwordx4 v[144:147], v1, s[32:35], s36 offen offset:0 nt
    s_waitcnt vmcnt(6)
    buffer_load_dwordx4 v[148:151], v1, s[32:35], s36 offen offset:1024 nt
    s_waitcnt vmcnt(6)
    buffer_load_dwordx4 v[152:155], v1, s[32:35], s36 offen offset:2048 nt
    v_mov_b32 v20, 10768
L_q_wait:
    ds_read_b32 v21, v20
    s_waitcnt lgkmcnt(0)
    v_readfirstlane_b32 s58, v21
    s_cmp_eq_u32 s58, 1
    s_cbranch_scc1 L_q_ok
    s_sleep 1
    s_add_u32 s78, s78, 1
    s_cmp_lt_u32 s78, 0x200000
    s_cbranch_scc1 L_q_wait
L_q_ok:
    ds_read_b128 v[6:9], v23 offset:10496
    s_add_u32 s66, s30, 0x9e3779b9
    s_add_u32 s67, s31, 0x7f4a7c15
    s_lshr_b32 s84, s66, 0
    s_lshr_b32 s85, s66, 4
    s_lshr_b32 s86, s66, 8
    s_lshr_b32 s87, s66, 12
    s_waitcnt lgkmcnt(0)
    s_mov_b32 s39, 0
    ds_read_b32 v246, v247 offset:13312
L_kloop:
    s_waitcnt lgkmcnt(0)
    v_cmp_le_i32 s[88:89], v246, v248
    v_cmp_le_i32 s[90:91], v246, v249
    s_nop 3
    s_waitcnt vmcnt(5)
    s_bitcmp1_b32 s88, 0
    s_cbranch_scc0 L_go1
    s_waitcnt vmcnt(4)
    s_bitcmp1_b32 s90, 0
    s_cbranch_scc0 L_go1
    s_waitcnt vmcnt(3)
L_go1:
    buffer_load_dwordx4 v[156:159], v1, s[32:35], s36 offen offset:3072 nt
    s_add_u32 s36, s36, 0x20000
    s_and_b32 s36, s36, 0x7fffff
    s_or_b32 s36, s36, s38
    s_add_u32 s37, s37, 1
    v_mov_b32 v242, s37
    ds_write_b32 v244, v242 offset:14336
    s_cmp_eq_u32 s37, 64
    s_cselect_b32 s32, s8, s32
    s_cselect_b32 s33, s9, s33
    v_dot2_f32_bf16 v12, v32, v6, 0
    v_dot2_f32_bf16 v12, v33, v7, v12
    v_dot2_f32_bf16 v12, v34, v8, v12
    v_dot2_f32_bf16 v12, v35, v9, v12
    s_waitcnt vmcnt(5)
    s_bitcmp1_b32 s88, 1
    s_cbranch_scc0 L_go2
    s_waitcnt vmcnt(4)
    s_bitcmp1_b32 s90, 1
    s_cbranch_scc0 L_go2
    s_waitcnt vmcnt(3)
L_go2:
    buffer_load_dwordx4 v[32:35], v1, s[32:35], s36 offen offset:0 nt
    v_dot2_f32_bf16 v13, v36, v6, 0
    v_dot2_f32_bf16 v13, v37, v7, v13
    v_dot2_f32_bf16 v13, v38, v8, v13
    v_dot2_f32_bf16 v13, v39, v9, v13
    s_waitcnt vmcnt(5)
    s_bitcmp1_b32 s88, 2
    s_cbranch_scc0 L_go3
    s_waitcnt vmcnt(4)
    s_bitcmp1_b32 s90, 2
    s_cbranch_scc0 L_go3
    s_waitcnt vmcnt(3)
L_go3:
    buffer_load_dwordx4 v[36:39], v1, s[32:35], s36 offen offset:1024 nt
    v_dot2_f32_bf16 v14, v40, v6, 0
    v_dot2_f32_bf16 v14, v41, v7, v14
    v_dot2_f32_bf16 v14, v42, v8, v14
    v_dot2_f32_bf16 v14, v43, v9, v14
    s_waitcnt vmcnt(5)
    s_bitcmp1_b32 s88, 3
    s_cbranch_scc0 L_go4
    s_waitcnt vmcnt(4)
    s_bitcmp1_b32 s90, 3
    s_cbranch_scc0 L_go4
    s_waitcnt vmcnt(3)
L_go4:
    buffer_load_dwordx4 v[40:43], v1, s[32:35], s36 offen offset:2048 nt
    v_dot2_f32_bf16 v15, v44, v6, 0
    v_dot2_f32_bf16 v15, v45, v7, v15
    v_dot2_f32_bf16 v15, v46, v8, v15
    v_dot2_f32_bf16 v15, v47, v9, v15
    v_add_f32_dpp v12, v12, v12 row_ror:8 row_mask:0xf bank_mask:0x3
    v_add_f32_dpp v13, v13, v13 row_ror:8 row_mask:0xf bank_mask:0x3
    s_nop 0
    v_add_f32_dpp v12, v14, v14 row_ror:8 row_mask:0xf bank_mask:0xc
    v_add_f32_dpp v13, v15, v15 row_ror:8 row_mask:0xf bank_mask:0xc
    s_nop 0
    v_add_f32_dpp v16, v12, v12 row_shl:4 row_mask:0xf bank_mask:0x5
    s_nop 1
    v_add_f32_dpp v16, v13, v13 row_shr:4 row_mask:0xf bank_mask:0xa
    s_waitcnt vmcnt(5)
    s_bitcmp1_b32 s88, 4
    s_cbranch_scc0 L_go5
    s_waitcnt vmcnt(4)
    s_bitcmp1_b32 s90, 4
    s_cbranch_scc0 L_go5
    s_waitcnt vmcnt(3)
L_go5:
    buffer_load_dwordx4 v[44:47], v1, s[32:35], s36 offen offset:3072 nt
    s_add_u32 s36, s36, 0x20000
    s_and_b32 s36, s36, 0x7fffff
    s_or_b32 s36, s36, s38
    s_add_u32 s37, s37, 1
    v_mov_b32 v242, s37
    ds_write_b32 v244, v242 offset:14336
    s_cmp_eq_u32 s37, 64
    s_cselect_b32 s32, s8, s32
    s_cselect_b32 s33, s9, s33
    v_dot2_f32_bf16 v12, v48, v6, 0
    v_dot2_f32_bf16 v12, v49, v7, v12
    v_dot2_f32_bf16 v12, v50, v8, v12
    v_dot2_f32_bf16 v12, v51, v9, v12
    s_waitcnt vmcnt(5)
    s_bitcmp1_b32 s88, 5
    s_cbranch_scc0 L_go6
    s_waitcnt vmcnt(4)
    s_bitcmp1_b32 s90, 5
    s_cbranch_scc0 L_go6
    s_waitcnt vmcnt(3)
L_go6:
    buffer_load_dwordx4 v[48:51], v1, s[32:35], s36 offen offset:0 nt
    v_dot2_f32_bf16 v13, v52, v6, 0
    v_dot2_f32_bf16 v13, v53, v7, v13
    v_dot2_f32_bf16 v13, v54, v8, v13
    v_dot2_f32_bf16 v13, v55, v9, v13
    s_waitcnt vmcnt(5)
    s_bitcmp1_b32 s88, 6
    s_cbranch_scc0 L_go7
    s_waitcnt vmcnt(4)
    s_bitcmp1_b32 s90, 6
    s_cbranch_scc0 L_go7
    s_waitcnt vmcnt(3)
L_go7:
    buffer_load_dwordx4 v[52:55], v1, s[32:35], s36 offen offset:1024 nt
    v_dot2_f32_bf16 v14, v56, v6, 0
    v_dot2_f32_bf16 v14, v57, v7, v14
    v_dot2_f32_bf16 v14, v58, v8, v14
    v_dot2_f32_bf16 v14, v59, v9, v14
    s_waitcnt vmcnt(5)
    s_bitcmp1_b32 s88, 7
    s_cbranch_scc0 L_go8
    s_waitcnt vmcnt(4)
    s_bitcmp1_b32 s90, 7
    s_cbranch_scc0 L_go8
    s_waitcnt vmcnt(3)
L_go8:
    buffer_load_dwordx4 v[56:59], v1, s[32:35], s36 offen offset:2048 nt
    v_dot2_f32_bf16 v15, v60, v6, 0
    v_dot2_f32_bf16 v15, v61, v7, v15
    v_dot2_f32_bf16 v15, v62, v8, v15
    v_dot2_f32_bf16 v15, v63, v9, v15
    v_add_f32_dpp v12, v12, v12 row_ror:8 row_mask:0xf bank_mask:0x3
    v_add_f32_dpp v13, v13, v13 row_ror:8 row_mask:0xf bank_mask:0x3
    s_nop 0
    v_add_f32_dpp v12, v14, v14 row_ror:8 row_mask:0xf bank_mask:0xc
    v_add_f32_dpp v13, v15, v15 row_ror:8 row_mask:0xf bank_mask:0xc
    s_nop 0
    v_add_f32_dpp v17, v12, v12 row_shl:4 row_mask:0xf bank_mask:0x5
    s_nop 1
    v_add_f32_dpp v17, v13, v13 row_shr:4 row_mask:0xf bank_mask:0xa
    s_waitcnt vmcnt(5)
    s_bitcmp1_b32 s88, 8
    s_cbranch_scc0 L_go9
    s_waitcnt vmcnt(4)
    s_bitcmp1_b32 s90, 8
    s_cbranch_scc0 L_go9
    s_waitcnt vmcnt(3)
L_go9:
    buffer_load_dwordx4 v[60:63], v1, s[32:35], s36 offen offset:3072 nt
    s_add_u32 s36, s36, 0x20000
    s_and_b32 s36, s36, 0x7fffff
    s_or_b32 s36, s36, s38
    s_add_u32 s37, s37, 1
    v_mov_b32 v242, s37
    ds_write_b32 v244, v242 offset:14336
    s_cmp_eq_u32 s37, 64
    s_cselect_b32 s32, s8, s32
    s_cselect_b32 s33, s9, s33
    v_dot2_f32_bf16 v12, v64, v6, 0
    v_dot2_f32_bf16 v12, v65, v7, v12
    v_dot2_f32_bf16 v12, v66, v8, v12
    v_dot2_f32_bf16 v12, v67, v9, v12
    ds_read_b32 v246, v247 offset:13312
    s_waitcnt vmcnt(5)
    s_bitcmp1_b32 s88, 9
    s_cbranch_scc0 L_go10
    s_waitcnt vmcnt(4)
    s_bitcmp1_b32 s90, 9
    s_cbranch_scc0 L_go10
    s_waitcnt vmcnt(3)
L_go10:
    buffer_load_dwordx4 v[64:67], v1, s[32:35], s36 offen offset:0 nt
    v_dot2_f32_bf16 v13, v68, v6, 0
    v_dot2_f32_bf16 v13, v69, v7, v13
    v_dot2_f32_bf16 v13, v70, v8, v13
    v_dot2_f32_bf16 v13, v71, v9, v13
    s_waitcnt vmcnt(5)
    s_bitcmp1_b32 s88, 10
    s_cbranch_scc0 L_go11
    s_waitcnt vmcnt(4)
    s_bitcmp1_b32 s90, 10
    s_cbranch_scc0 L_go11
    s_waitcnt vmcnt(3)
L_go11:
    buffer_load_dwordx4 v[68:71], v1, s[32:35], s36 offen offset:1024 nt
    v_dot2_f32_bf16 v14, v72, v6, 0
    v_dot2_f32_bf16 v14, v73, v7, v14
    v_dot2_f32_bf16 v14, v74, v8, v14
    v_dot2_f32_bf16 v14, v75, v9, v14
    s_waitcnt vmcnt(5)
    s_bitcmp1_b32 s88, 11
    s_cbranch_scc0 L_go12
    s_waitcnt vmcnt(4)
    s_bitcmp1_b32 s90, 11
    s_cbranch_scc0 L_go12
    s_waitcnt vmcnt(3)
L_go12:
    buffer_load_dwordx4 v[72:75], v1, s[32:35], s36 offen offset:2048 nt
    v_dot2_f32_bf16 v15, v76, v6, 0
    v_dot2_f32_bf16 v15, v77, v7, v15
    v_dot2_f32_bf16 v15, v78, v8, v15
    v_dot2_f32_bf16 v15, v79, v9, v15
    v_add_f32_dpp v12, v12, v12 row_ror:8 row_mask:0xf bank_mask:0x3
    v_add_f32_dpp v13, v13, v13 row_ror:8 row_mask:0xf bank_mask:0x3
    s_nop 0
    v_add_f32_dpp v12, v14, v14 row_ror:8 row_mask:0xf bank_mask:0xc
    v_add_f32_dpp v13, v15, v15 row_ror:8 row_mask:0xf bank_mask:0xc
    s_nop 0
    v_add_f32_dpp v18, v12, v12 row_shl:4 row_mask:0xf bank_mask:0x5
    s_nop 1
    v_add_f32_dpp v18, v13, v13 row_shr:4 row_mask:0xf bank_mask:0xa
    s_waitcnt vmcnt(5)
    s_bitcmp1_b32 s88, 12
    s_cbranch_scc0 L_go13
    s_waitcnt vmcnt(4)
    s_bitcmp1_b32 s90, 12
    s_cbranch_scc0 L_go13
    s_waitcnt vmcnt(3)
L_go13:
    buffer_load_dwordx4 v[76:79], v1, s[32:35], s36 offen offset:3072 nt
    s_add_u32 s36, s36, 0x20000
    s_and_b32 s36, s36, 0x7fffff
    s_or_b32 s36, s36, s38
    s_add_u32 s37, s37, 1
    v_mov_b32 v242, s37
    ds_write_b32 v244, v242 offset:14336
    s_cmp_eq_u32 s37, 64
    s_cselect_b32 s32, s8, s32
    s_cselect_b32 s33, s9, s33
    v_dot2_f32_bf16 v12, v80, v6, 0
    v_dot2_f32_bf16 v12, v81, v7, v12
    v_dot2_f32_bf16 v12, v82, v8, v12
    v_dot2_f32_bf16 v12, v83, v9, v12
    s_waitcnt vmcnt(5)
    s_bitcmp1_b32 s88, 13
    s_cbranch_scc0 L_go14
    s_waitcnt vmcnt(4)
    s_bitcmp1_b32 s90, 13
    s_cbranch_scc0 L_go14
    s_waitcnt vmcnt(3)
L_go14:
    buffer_load_dwordx4 v[80:83], v1, s[32:35], s36 offen offset:0 nt
    v_dot2_f32_bf16 v13, v84, v6, 0
    v_dot2_f32_bf16 v13, v85, v7, v13
    v_dot2_f32_bf16 v13, v86, v8, v13
    v_dot2_f32_bf16 v13, v87, v9, v13
    s_waitcnt vmcnt(5)
    s_bitcmp1_b32 s88, 14
    s_cbranch_scc0 L_go15
    s_waitcnt vmcnt(4)
    s_bitcmp1_b32 s90, 14
    s_cbranch_scc0 L_go15
    s_waitcnt vmcnt(3)
L_go15:
    buffer_load_dwordx4 v[84:87], v1, s[32:35], s36 offen offset:1024 nt
    v_dot2_f32_bf16 v14, v88, v6, 0
    v_dot2_f32_bf16 v14, v89, v7, v14
    v_dot2_f32_bf16 v14, v90, v8, v14
    v_dot2_f32_bf16 v14, v91, v9, v14
    s_waitcnt vmcnt(5)
    s_bitcmp1_b32 s88, 15
    s_cbranch_scc0 L_go16
    s_waitcnt vmcnt(4)
    s_bitcmp1_b32 s90, 15
    s_cbranch_scc0 L_go16
    s_waitcnt vmcnt(3)
L_go16:
    buffer_load_dwordx4 v[88:91], v1, s[32:35], s36 offen offset:2048 nt
    v_dot2_f32_bf16 v15, v92, v6, 0
    v_dot2_f32_bf16 v15, v93, v7, v15
    v_dot2_f32_bf16 v15, v94, v8, v15
    v_dot2_f32_bf16 v15, v95, v9, v15
    v_add_f32_dpp v12, v12, v12 row_ror:8 row_mask:0xf bank_mask:0x3
    v_add_f32_dpp v13, v13, v13 row_ror:8 row_mask:0xf bank_mask:0x3
    s_nop 0
    v_add_f32_dpp v12, v14, v14 row_ror:8 row_mask:0xf bank_mask:0xc
    v_add_f32_dpp v13, v15, v15 row_ror:8 row_mask:0xf bank_mask:0xc
    s_nop 0
    v_add_f32_dpp v19, v12, v12 row_shl:4 row_mask:0xf bank_mask:0x5
    s_nop 1
    v_add_f32_dpp v19, v13, v13 row_shr:4 row_mask:0xf bank_mask:0xa
    v_add_f32_dpp v16, v16, v16 quad_perm:[1,0,3,2] row_mask:0xf bank_mask:0xf
    v_add_f32_dpp v17, v17, v17 quad_perm:[1,0,3,2] row_mask:0xf bank_mask:0xf
    v_add_f32_dpp v18, v18, v18 quad_perm:[1,0,3,2] row_mask:0xf bank_mask:0xf
    v_add_f32_dpp v19, v19, v19 quad_perm:[1,0,3,2] row_mask:0xf bank_mask:0xf
    v_cndmask_b32 v16, v16, v17, s[60:61]
    v_cndmask_b32 v18, v18, v19, s[60:61]
    s_nop 0
    v_add_f32_dpp v16, v16, v16 quad_perm:[2,3,0,1] row_mask:0xf bank_mask:0xf
    v_add_f32_dpp v18, v18, v18 quad_perm:[2,3,0,1] row_mask:0xf bank_mask:0xf
    v_cndmask_b32 v20, v16, v18, s[62:63]
    v_cvt_pk_bf16_f32 v20, v20, v20
    v_and_b32 v20, 0xffff0000, v20
    v_mul_f32 v20, s64, v20
    v_cvt_pk_bf16_f32 v20, v20, v20
    v_and_b32 v20, 0xffff0000, v20
    v_max_f32 v10, v10, v20
    ds_write_b16_d16_hi v11, v20
    v_add_u32 v11, 128, v11
    s_waitcnt lgkmcnt(0)
    v_cmp_le_i32 s[88:89], v246, v248
    v_cmp_le_i32 s[90:91], v246, v249
    s_nop 3
    s_waitcnt vmcnt(5)
    s_bitcmp1_b32 s88, 0
    s_cbranch_scc0 L_go17
    s_waitcnt vmcnt(4)
    s_bitcmp1_b32 s90, 0
    s_cbranch_scc0 L_go17
    s_waitcnt vmcnt(3)
L_go17:
    buffer_load_dwordx4 v[92:95], v1, s[32:35], s36 offen offset:3072 nt
    s_add_u32 s36, s36, 0x20000
    s_and_b32 s36, s36, 0x7fffff
    s_or_b32 s36, s36, s38
    s_add_u32 s37, s37, 1
    v_mov_b32 v242, s37
    ds_write_b32 v244, v242 offset:14336
    s_cmp_eq_u32 s37, 64
    s_cselect_b32 s32, s8, s32
    s_cselect_b32 s33, s9, s33
    v_dot2_f32_bf16 v12, v96, v6, 0
    v_dot2_f32_bf16 v12, v97, v7, v12
    v_dot2_f32_bf16 v12, v98, v8, v12
    v_dot2_f32_bf16 v12, v99, v9, v12
    s_waitcnt vmcnt(5)
    s_bitcmp1_b32 s88, 1
    s_cbranch_scc0 L_go18
    s_waitcnt vmcnt(4)
    s_bitcmp1_b32 s90, 1
    s_cbranch_scc0 L_go18
    s_waitcnt vmcnt(3)
L_go18:
    buffer_load_dwordx4 v[96:99], v1, s[32:35], s36 offen offset:0 nt
    v_dot2_f32_bf16 v13, v100, v6, 0
    v_dot2_f32_bf16 v13, v101, v7, v13
    v_dot2_f32_bf16 v13, v102, v8, v13
    v_dot2_f32_bf16 v13, v103, v9, v13
    s_waitcnt vmcnt(5)
    s_bitcmp1_b32 s88, 2
    s_cbranch_scc0 L_go19
    s_waitcnt vmcnt(4)
    s_bitcmp1_b32 s90, 2
    s_cbranch_scc0 L_go19
    s_waitcnt vmcnt(3)
L_go19:
    buffer_load_dwordx4 v[100:103], v1, s[32:35], s36 offen offset:1024 nt
    v_dot2_f32_bf16 v14, v104, v6, 0
    v_dot2_f32_bf16 v14, v105, v7, v14
    v_dot2_f32_bf16 v14, v106, v8, v14
    v_dot2_f32_bf16 v14, v107, v9, v14
    s_waitcnt vmcnt(5)
    s_bitcmp1_b32 s88, 3
    s_cbranch_scc0 L_go20
    s_waitcnt vmcnt(4)
    s_bitcmp1_b32 s90, 3
    s_cbranch_scc0 L_go20
    s_waitcnt vmcnt(3)
L_go20:
    buffer_load_dwordx4 v[104:107], v1, s[32:35], s36 offen offset:2048 nt
    v_dot2_f32_bf16 v15, v108, v6, 0
    v_dot2_f32_bf16 v15, v109, v7, v15
    v_dot2_f32_bf16 v15, v110, v8, v15
    v_dot2_f32_bf16 v15, v111, v9, v15
    v_add_f32_dpp v12, v12, v12 row_ror:8 row_mask:0xf bank_mask:0x3
    v_add_f32_dpp v13, v13, v13 row_ror:8 row_mask:0xf bank_mask:0x3
    s_nop 0
    v_add_f32_dpp v12, v14, v14 row_ror:8 row_mask:0xf bank_mask:0xc
    v_add_f32_dpp v13, v15, v15 row_ror:8 row_mask:0xf bank_mask:0xc
    s_nop 0
    v_add_f32_dpp v16, v12, v12 row_shl:4 row_mask:0xf bank_mask:0x5
    s_nop 1
    v_add_f32_dpp v16, v13, v13 row_shr:4 row_mask:0xf bank_mask:0xa
    s_waitcnt vmcnt(5)
    s_bitcmp1_b32 s88, 4
    s_cbranch_scc0 L_go21
    s_waitcnt vmcnt(4)
    s_bitcmp1_b32 s90, 4
    s_cbranch_scc0 L_go21
    s_waitcnt vmcnt(3)
L_go21:
    buffer_load_dwordx4 v[108:111], v1, s[32:35], s36 offen offset:3072 nt
    s_add_u32 s36, s36, 0x20000
    s_and_b32 s36, s36, 0x7fffff
    s_or_b32 s36, s36, s38
    s_add_u32 s37, s37, 1
    v_mov_b32 v242, s37
    ds_write_b32 v244, v242 offset:14336
    s_cmp_eq_u32 s37, 64
    s_cselect_b32 s32, s8, s32
    s_cselect_b32 s33, s9, s33
    v_dot2_f32_bf16 v12, v112, v6, 0
    v_dot2_f32_bf16 v12, v113, v7, v12
    v_dot2_f32_bf16 v12, v114, v8, v12
    v_dot2_f32_bf16 v12, v115, v9, v12
    s_waitcnt vmcnt(5)
    s_bitcmp1_b32 s88, 5
    s_cbranch_scc0 L_go22
    s_waitcnt vmcnt(4)
    s_bitcmp1_b32 s90, 5
    s_cbranch_scc0 L_go22
    s_waitcnt vmcnt(3)
L_go22:
    buffer_load_dwordx4 v[112:115], v1, s[32:35], s36 offen offset:0 nt
    v_dot2_f32_bf16 v13, v116, v6, 0
    v_dot2_f32_bf16 v13, v117, v7, v13
    v_dot2_f32_bf16 v13, v118, v8, v13
    v_dot2_f32_bf16 v13, v119, v9, v13
    s_waitcnt vmcnt(5)
    s_bitcmp1_b32 s88, 6
    s_cbranch_scc0 L_go23
    s_waitcnt vmcnt(4)
    s_bitcmp1_b32 s90, 6
    s_cbranch_scc0 L_go23
    s_waitcnt vmcnt(3)
L_go23:
    buffer_load_dwordx4 v[116:119], v1, s[32:35], s36 offen offset:1024 nt
    v_dot2_f32_bf16 v14, v120, v6, 0
    v_dot2_f32_bf16 v14, v121, v7, v14
    v_dot2_f32_bf16 v14, v122, v8, v14
    v_dot2_f32_bf16 v14, v123, v9, v14
    s_waitcnt vmcnt(5)
    s_bitcmp1_b32 s88, 7
    s_cbranch_scc0 L_go24
    s_waitcnt vmcnt(4)
    s_bitcmp1_b32 s90, 7
    s_cbranch_scc0 L_go24
    s_waitcnt vmcnt(3)
L_go24:
    buffer_load_dwordx4 v[120:123], v1, s[32:35], s36 offen offset:2048 nt
    v_dot2_f32_bf16 v15, v124, v6, 0
    v_dot2_f32_bf16 v15, v125, v7, v15
    v_dot2_f32_bf16 v15, v126, v8, v15
    v_dot2_f32_bf16 v15, v127, v9, v15
    v_add_f32_dpp v12, v12, v12 row_ror:8 row_mask:0xf bank_mask:0x3
    v_add_f32_dpp v13, v13, v13 row_ror:8 row_mask:0xf bank_mask:0x3
    s_nop 0
    v_add_f32_dpp v12, v14, v14 row_ror:8 row_mask:0xf bank_mask:0xc
    v_add_f32_dpp v13, v15, v15 row_ror:8 row_mask:0xf bank_mask:0xc
    s_nop 0
    v_add_f32_dpp v17, v12, v12 row_shl:4 row_mask:0xf bank_mask:0x5
    s_nop 1
    v_add_f32_dpp v17, v13, v13 row_shr:4 row_mask:0xf bank_mask:0xa
    s_waitcnt vmcnt(5)
    s_bitcmp1_b32 s88, 8
    s_cbranch_scc0 L_go25
    s_waitcnt vmcnt(4)
    s_bitcmp1_b32 s90, 8
    s_cbranch_scc0 L_go25
    s_waitcnt vmcnt(3)
L_go25:
    buffer_load_dwordx4 v[124:127], v1, s[32:35], s36 offen offset:3072 nt
    s_add_u32 s36, s36, 0x20000
    s_and_b32 s36, s36, 0x7fffff
    s_or_b32 s36, s36, s38
    s_add_u32 s37, s37, 1
    v_mov_b32 v242, s37
    ds_write_b32 v244, v242 offset:14336
    s_cmp_eq_u32 s37, 64
    s_cselect_b32 s32, s8, s32
    s_cselect_b32 s33, s9, s33
    v_dot2_f32_bf16 v12, v128, v6, 0
    v_dot2_f32_bf16 v12, v129, v7, v12
    v_dot2_f32_bf16 v12, v130, v8, v12
    v_dot2_f32_bf16 v12, v131, v9, v12
    ds_read_b32 v246, v247 offset:13312
    s_waitcnt vmcnt(5)
    s_bitcmp1_b32 s88, 9
    s_cbranch_scc0 L_go26
    s_waitcnt vmcnt(4)
    s_bitcmp1_b32 s90, 9
    s_cbranch_scc0 L_go26
    s_waitcnt vmcnt(3)
L_go26:
    buffer_load_dwordx4 v[128:131], v1, s[32:35], s36 offen offset:0 nt
    v_dot2_f32_bf16 v13, v132, v6, 0
    v_dot2_f32_bf16 v13, v133, v7, v13
    v_dot2_f32_bf16 v13, v134, v8, v13
    v_dot2_f32_bf16 v13, v135, v9, v13
    s_waitcnt vmcnt(5)
    s_bitcmp1_b32 s88, 10
    s_cbranch_scc0 L_go27
    s_waitcnt vmcnt(4)
    s_bitcmp1_b32 s90, 10
    s_cbranch_scc0 L_go27
    s_waitcnt vmcnt(3)
L_go27:
    buffer_load_dwordx4 v[132:135], v1, s[32:35], s36 offen offset:1024 nt
    v_dot2_f32_bf16 v14, v136, v6, 0
    v_dot2_f32_bf16 v14, v137, v7, v14
    v_dot2_f32_bf16 v14, v138, v8, v14
    v_dot2_f32_bf16 v14, v139, v9, v14
    s_waitcnt vmcnt(5)
    s_bitcmp1_b32 s88, 11
    s_cbranch_scc0 L_go28
    s_waitcnt vmcnt(4)
    s_bitcmp1_b32 s90, 11
    s_cbranch_scc0 L_go28
    s_waitcnt vmcnt(3)
L_go28:
    buffer_load_dwordx4 v[136:139], v1, s[32:35], s36 offen offset:2048 nt
    v_dot2_f32_bf16 v15, v140, v6, 0
    v_dot2_f32_bf16 v15, v141, v7, v15
    v_dot2_f32_bf16 v15, v142, v8, v15
    v_dot2_f32_bf16 v15, v143, v9, v15
    v_add_f32_dpp v12, v12, v12 row_ror:8 row_mask:0xf bank_mask:0x3
    v_add_f32_dpp v13, v13, v13 row_ror:8 row_mask:0xf bank_mask:0x3
    s_nop 0
    v_add_f32_dpp v12, v14, v14 row_ror:8 row_mask:0xf bank_mask:0xc
    v_add_f32_dpp v13, v15, v15 row_ror:8 row_mask:0xf bank_mask:0xc
    s_nop 0
    v_add_f32_dpp v18, v12, v12 row_shl:4 row_mask:0xf bank_mask:0x5
    s_nop 1
    v_add_f32_dpp v18, v13, v13 row_shr:4 row_mask:0xf bank_mask:0xa
    s_waitcnt vmcnt(5)
    s_bitcmp1_b32 s88, 12
    s_cbranch_scc0 L_go29
    s_waitcnt vmcnt(4)
    s_bitcmp1_b32 s90, 12
    s_cbranch_scc0 L_go29
    s_waitcnt vmcnt(3)
L_go29:
    buffer_load_dwordx4 v[140:143], v1, s[32:35], s36 offen offset:3072 nt
    s_add_u32 s36, s36, 0x20000
    s_and_b32 s36, s36, 0x7fffff
    s_or_b32 s36, s36, s38
    s_add_u32 s37, s37, 1
    v_mov_b32 v242, s37
    ds_write_b32 v244, v242 offset:14336
    s_cmp_eq_u32 s37, 64
    s_cselect_b32 s32, s8, s32
    s_cselect_b32 s33, s9, s33
    v_dot2_f32_bf16 v12, v144, v6, 0
    v_dot2_f32_bf16 v12, v145, v7, v12
    v_dot2_f32_bf16 v12, v146, v8, v12
    v_dot2_f32_bf16 v12, v147, v9, v12
    s_waitcnt vmcnt(5)
    s_bitcmp1_b32 s88, 13
    s_cbranch_scc0 L_go30
    s_waitcnt vmcnt(4)
    s_bitcmp1_b32 s90, 13
    s_cbranch_scc0 L_go30
    s_waitcnt vmcnt(3)
L_go30:
    buffer_load_dwordx4 v[144:147], v1, s[32:35], s36 offen offset:0 nt
    v_dot2_f32_bf16 v13, v148, v6, 0
    v_dot2_f32_bf16 v13, v149, v7, v13
    v_dot2_f32_bf16 v13, v150, v8, v13
    v_dot2_f32_bf16 v13, v151, v9, v13
    s_waitcnt vmcnt(5)
    s_bitcmp1_b32 s88, 14
    s_cbranch_scc0 L_go31
    s_waitcnt vmcnt(4)
    s_bitcmp1_b32 s90, 14
    s_cbranch_scc0 L_go31
    s_waitcnt vmcnt(3)
L_go31:
    buffer_load_dwordx4 v[148:151], v1, s[32:35], s36 offen offset:1024 nt
    v_dot2_f32_bf16 v14, v152, v6, 0
    v_dot2_f32_bf16 v14, v153, v7, v14
    v_dot2_f32_bf16 v14, v154, v8, v14
    v_dot2_f32_bf16 v14, v155, v9, v14
    s_waitcnt vmcnt(5)
    s_bitcmp1_b32 s88, 15
    s_cbranch_scc0 L_go32
    s_waitcnt vmcnt(4)
    s_bitcmp1_b32 s90, 15
    s_cbranch_scc0 L_go32
    s_waitcnt vmcnt(3)
L_go32:
    buffer_load_dwordx4 v[152:155], v1, s[32:35], s36 offen offset:2048 nt
    v_dot2_f32_bf16 v15, v156, v6, 0
    v_dot2_f32_bf16 v15, v157, v7, v15
    v_dot2_f32_bf16 v15, v158, v8, v15
    v_dot2_f32_bf16 v15, v159, v9, v15
    v_add_f32_dpp v12, v12, v12 row_ror:8 row_mask:0xf bank_mask:0x3
    v_add_f32_dpp v13, v13, v13 row_ror:8 row_mask:0xf bank_mask:0x3
    s_nop 0
    v_add_f32_dpp v12, v14, v14 row_ror:8 row_mask:0xf bank_mask:0xc
    v_add_f32_dpp v13, v15, v15 row_ror:8 row_mask:0xf bank_mask:0xc
    s_nop 0
    v_add_f32_dpp v19, v12, v12 row_shl:4 row_mask:0xf bank_mask:0x5
    s_nop 1
    v_add_f32_dpp v19, v13, v13 row_shr:4 row_mask:0xf bank_mask:0xa
    v_add_f32_dpp v16, v16, v16 quad_perm:[1,0,3,2] row_mask:0xf bank_mask:0xf
    v_add_f32_dpp v17, v17, v17 quad_perm:[1,0,3,2] row_mask:0xf bank_mask:0xf
    v_add_f32_dpp v18, v18, v18 quad_perm:[1,0,3,2] row_mask:0xf bank_mask:0xf
    v_add_f32_dpp v19, v19, v19 quad_perm:[1,0,3,2] row_mask:0xf bank_mask:0xf
    v_cndmask_b32 v16, v16, v17, s[60:61]
    v_cndmask_b32 v18, v18, v19, s[60:61]
    s_nop 0
    v_add_f32_dpp v16, v16, v16 quad_perm:[2,3,0,1] row_mask:0xf bank_mask:0xf
    v_add_f32_dpp v18, v18, v18 quad_perm:[2,3,0,1] row_mask:0xf bank_mask:0xf
    v_cndmask_b32 v20, v16, v18, s[62:63]
    v_cvt_pk_bf16_f32 v20, v20, v20
    v_and_b32 v20, 0xffff0000, v20
    v_mul_f32 v20, s64, v20
    v_cvt_pk_bf16_f32 v20, v20, v20
    v_and_b32 v20, 0xffff0000, v20
    v_max_f32 v10, v10, v20
    ds_write_b16_d16_hi v11, v20
    v_add_u32 v11, 128, v11
    s_add_u32 s39, s39, 1
    s_cmp_lt_u32 s39, 8
    s_cbranch_scc1 L_kloop
    ds_read_u16_d16_hi v245, v22
    v_add_u32 v22, 128, v22
    s_nop 1
    v_max_f32_dpp v10, v10, v10 row_ror:8 row_mask:0xf bank_mask:0xf
    s_nop 1
    v_max_f32_dpp v10, v10, v10 row_ror:4 row_mask:0xf bank_mask:0xf
    s_nop 1
    v_max_f32_dpp v10, v10, v10 row_ror:2 row_mask:0xf bank_mask:0xf
    s_nop 1
    v_max_f32_dpp v10, v10, v10 row_ror:1 row_mask:0xf bank_mask:0xf
    v_mov_b32 v20, v10
    s_nop 1
    v_permlane16_swap_b32 v10, v20
    v_max_f32 v10, v10, v20
    v_mov_b32 v20, v10
    s_nop 1
    v_permlane32_swap_b32 v10, v20
    v_max_f32 v10, v10, v20
    v_mul_f32_e64 v23, -v10, s65
    v_min_u32 v10, -2, v10
    s_lshl_b32 s58, s52, 2
    v_mov_b32 v240, s58
    s_mov_b64 exec, 1
    ds_write_b32 v240, v10 offset:10752
    s_mov_b64 exec, -1
    s_mov_b32 s39, 0
L_vloop:
    s_waitcnt lgkmcnt(0)
    v_cmp_le_i32 s[88:89], v246, v248
    v_cmp_le_i32 s[90:91], v246, v249
    v_fma_f32 v20, v245, s65, v23
    v_exp_f32 v20, v20
    s_nop 0
    v_cvt_pk_bf16_f32 v241, v20, v20
    s_waitcnt vmcnt(5)
    s_bitcmp1_b32 s88, 0
    s_cbranch_scc0 L_go33
    s_waitcnt vmcnt(4)
    s_bitcmp1_b32 s90, 0
    s_cbranch_scc0 L_go33
    s_waitcnt vmcnt(3)
L_go33:
    buffer_load_dwordx4 v[156:159], v1, s[32:35], s36 offen offset:3072 nt
    s_add_u32 s36, s36, 0x20000
    s_and_b32 s36, s36, 0x7fffff
    s_or_b32 s36, s36, s38
    s_add_u32 s37, s37, 1
    v_mov_b32 v242, s37
    ds_write_b32 v244, v242 offset:14336
    s_cmp_eq_u32 s37, 64
    s_cselect_b32 s32, s8, s32
    s_cselect_b32 s33, s9, s33
    v_and_b32_dpp v28, v241, v2 row_newbcast:0 row_mask:0xf bank_mask:0xf
    v_and_b32_dpp v29, v241, v3 row_newbcast:0 row_mask:0xf bank_mask:0xf
    v_and_b32_dpp v30, v241, v4 row_newbcast:0 row_mask:0xf bank_mask:0xf
    v_and_b32_dpp v31, v241, v5 row_newbcast:0 row_mask:0xf bank_mask:0xf
    s_nop 1
    v_mfma_f32_16x16x32_bf16 v[24:27], v[28:31], v[32:35], v[24:27]
    s_waitcnt vmcnt(5)
    s_bitcmp1_b32 s88, 1
    s_cbranch_scc0 L_go34
    s_waitcnt vmcnt(4)
    s_bitcmp1_b32 s90, 1
    s_cbranch_scc0 L_go34
    s_waitcnt vmcnt(3)
L_go34:
    buffer_load_dwordx4 v[32:35], v1, s[32:35], s36 offen offset:0 nt
    v_and_b32_dpp v28, v241, v2 row_newbcast:4 row_mask:0xf bank_mask:0xf
    v_and_b32_dpp v29, v241, v3 row_newbcast:4 row_mask:0xf bank_mask:0xf
    v_and_b32_dpp v30, v241, v4 row_newbcast:4 row_mask:0xf bank_mask:0xf
    v_and_b32_dpp v31, v241, v5 row_newbcast:4 row_mask:0xf bank_mask:0xf
    s_nop 1
    v_mfma_f32_16x16x32_bf16 v[24:27], v[28:31], v[36:39], v[24:27]
    s_waitcnt vmcnt(5)
    s_bitcmp1_b32 s88, 2
    s_cbranch_scc0 L_go35
    s_waitcnt vmcnt(4)
    s_bitcmp1_b32 s90, 2
    s_cbranch_scc0 L_go35
    s_waitcnt vmcnt(3)
L_go35:
    buffer_load_dwordx4 v[36:39], v1, s[32:35], s36 offen offset:1024 nt
    v_and_b32_dpp v28, v241, v2 row_newbcast:8 row_mask:0xf bank_mask:0xf
    v_and_b32_dpp v29, v241, v3 row_newbcast:8 row_mask:0xf bank_mask:0xf
    v_and_b32_dpp v30, v241, v4 row_newbcast:8 row_mask:0xf bank_mask:0xf
    v_and_b32_dpp v31, v241, v5 row_newbcast:8 row_mask:0xf bank_mask:0xf
    s_nop 1
    v_mfma_f32_16x16x32_bf16 v[24:27], v[28:31], v[40:43], v[24:27]
    s_waitcnt vmcnt(5)
    s_bitcmp1_b32 s88, 3
    s_cbranch_scc0 L_go36
    s_waitcnt vmcnt(4)
    s_bitcmp1_b32 s90, 3
    s_cbranch_scc0 L_go36
    s_waitcnt vmcnt(3)
L_go36:
    buffer_load_dwordx4 v[40:43], v1, s[32:35], s36 offen offset:2048 nt
    v_and_b32_dpp v28, v241, v2 row_newbcast:12 row_mask:0xf bank_mask:0xf
    v_and_b32_dpp v29, v241, v3 row_newbcast:12 row_mask:0xf bank_mask:0xf
    v_and_b32_dpp v30, v241, v4 row_newbcast:12 row_mask:0xf bank_mask:0xf
    v_and_b32_dpp v31, v241, v5 row_newbcast:12 row_mask:0xf bank_mask:0xf
    s_nop 1
    v_mfma_f32_16x16x32_bf16 v[24:27], v[28:31], v[44:47], v[24:27]
    s_waitcnt vmcnt(5)
    s_bitcmp1_b32 s88, 4
    s_cbranch_scc0 L_go37
    s_waitcnt vmcnt(4)
    s_bitcmp1_b32 s90, 4
    s_cbranch_scc0 L_go37
    s_waitcnt vmcnt(3)
L_go37:
    buffer_load_dwordx4 v[44:47], v1, s[32:35], s36 offen offset:3072 nt
    s_add_u32 s36, s36, 0x20000
    s_and_b32 s36, s36, 0x7fffff
    s_or_b32 s36, s36, s38
    s_add_u32 s37, s37, 1
    v_mov_b32 v242, s37
    ds_write_b32 v244, v242 offset:14336
    s_cmp_eq_u32 s37, 64
    s_cselect_b32 s32, s8, s32
    s_cselect_b32 s33, s9, s33
    v_and_b32_dpp v28, v241, v2 row_newbcast:1 row_mask:0xf bank_mask:0xf
    v_and_b32_dpp v29, v241, v3 row_newbcast:1 row_mask:0xf bank_mask:0xf
    v_and_b32_dpp v30, v241, v4 row_newbcast:1 row_mask:0xf bank_mask:0xf
    v_and_b32_dpp v31, v241, v5 row_newbcast:1 row_mask:0xf bank_mask:0xf
    s_nop 1
    v_mfma_f32_16x16x32_bf16 v[24:27], v[28:31], v[48:51], v[24:27]
    s_waitcnt vmcnt(5)
    s_bitcmp1_b32 s88, 5
    s_cbranch_scc0 L_go38
    s_waitcnt vmcnt(4)
    s_bitcmp1_b32 s90, 5
    s_cbranch_scc0 L_go38
    s_waitcnt vmcnt(3)
L_go38:
    buffer_load_dwordx4 v[48:51], v1, s[32:35], s36 offen offset:0 nt
    v_and_b32_dpp v28, v241, v2 row_newbcast:5 row_mask:0xf bank_mask:0xf
    v_and_b32_dpp v29, v241, v3 row_newbcast:5 row_mask:0xf bank_mask:0xf
    v_and_b32_dpp v30, v241, v4 row_newbcast:5 row_mask:0xf bank_mask:0xf
    v_and_b32_dpp v31, v241, v5 row_newbcast:5 row_mask:0xf bank_mask:0xf
    s_nop 1
    v_mfma_f32_16x16x32_bf16 v[24:27], v[28:31], v[52:55], v[24:27]
    s_waitcnt vmcnt(5)
    s_bitcmp1_b32 s88, 6
    s_cbranch_scc0 L_go39
    s_waitcnt vmcnt(4)
    s_bitcmp1_b32 s90, 6
    s_cbranch_scc0 L_go39
    s_waitcnt vmcnt(3)
L_go39:
    buffer_load_dwordx4 v[52:55], v1, s[32:35], s36 offen offset:1024 nt
    v_and_b32_dpp v28, v241, v2 row_newbcast:9 row_mask:0xf bank_mask:0xf
    v_and_b32_dpp v29, v241, v3 row_newbcast:9 row_mask:0xf bank_mask:0xf
    v_and_b32_dpp v30, v241, v4 row_newbcast:9 row_mask:0xf bank_mask:0xf
    v_and_b32_dpp v31, v241, v5 row_newbcast:9 row_mask:0xf bank_mask:0xf
    s_nop 1
    v_mfma_f32_16x16x32_bf16 v[24:27], v[28:31], v[56:59], v[24:27]
    s_waitcnt vmcnt(5)
    s_bitcmp1_b32 s88, 7
    s_cbranch_scc0 L_go40
    s_waitcnt vmcnt(4)
    s_bitcmp1_b32 s90, 7
    s_cbranch_scc0 L_go40
    s_waitcnt vmcnt(3)
L_go40:
    buffer_load_dwordx4 v[56:59], v1, s[32:35], s36 offen offset:2048 nt
    v_and_b32_dpp v28, v241, v2 row_newbcast:13 row_mask:0xf bank_mask:0xf
    v_and_b32_dpp v29, v241, v3 row_newbcast:13 row_mask:0xf bank_mask:0xf
    v_and_b32_dpp v30, v241, v4 row_newbcast:13 row_mask:0xf bank_mask:0xf
    v_and_b32_dpp v31, v241, v5 row_newbcast:13 row_mask:0xf bank_mask:0xf
    s_nop 1
    v_mfma_f32_16x16x32_bf16 v[24:27], v[28:31], v[60:63], v[24:27]
    s_waitcnt vmcnt(5)
    s_bitcmp1_b32 s88, 8
    s_cbranch_scc0 L_go41
    s_waitcnt vmcnt(4)
    s_bitcmp1_b32 s90, 8
    s_cbranch_scc0 L_go41
    s_waitcnt vmcnt(3)
L_go41:
    buffer_load_dwordx4 v[60:63], v1, s[32:35], s36 offen offset:3072 nt
    s_add_u32 s36, s36, 0x20000
    s_and_b32 s36, s36, 0x7fffff
    s_or_b32 s36, s36, s38
    s_add_u32 s37, s37, 1
    v_mov_b32 v242, s37
    ds_write_b32 v244, v242 offset:14336
    s_cmp_eq_u32 s37, 64
    s_cselect_b32 s32, s8, s32
    s_cselect_b32 s33, s9, s33
    v_and_b32_dpp v28, v241, v2 row_newbcast:2 row_mask:0xf bank_mask:0xf
    v_and_b32_dpp v29, v241, v3 row_newbcast:2 row_mask:0xf bank_mask:0xf
    v_and_b32_dpp v30, v241, v4 row_newbcast:2 row_mask:0xf bank_mask:0xf
    v_and_b32_dpp v31, v241, v5 row_newbcast:2 row_mask:0xf bank_mask:0xf
    s_nop 1
    v_mfma_f32_16x16x32_bf16 v[24:27], v[28:31], v[64:67], v[24:27]
    ds_read_u16_d16_hi v245, v22
    v_add_u32 v22, 128, v22
    ds_read_b32 v246, v247 offset:13312
    s_waitcnt vmcnt(5)
    s_bitcmp1_b32 s88, 9
    s_cbranch_scc0 L_go42
    s_waitcnt vmcnt(4)
    s_bitcmp1_b32 s90, 9
    s_cbranch_scc0 L_go42
    s_waitcnt vmcnt(3)
L_go42:
    buffer_load_dwordx4 v[64:67], v1, s[32:35], s36 offen offset:0 nt
    v_and_b32_dpp v28, v241, v2 row_newbcast:6 row_mask:0xf bank_mask:0xf
    v_and_b32_dpp v29, v241, v3 row_newbcast:6 row_mask:0xf bank_mask:0xf
    v_and_b32_dpp v30, v241, v4 row_newbcast:6 row_mask:0xf bank_mask:0xf
    v_and_b32_dpp v31, v241, v5 row_newbcast:6 row_mask:0xf bank_mask:0xf
    s_nop 1
    v_mfma_f32_16x16x32_bf16 v[24:27], v[28:31], v[68:71], v[24:27]
    s_waitcnt vmcnt(5)
    s_bitcmp1_b32 s88, 10
    s_cbranch_scc0 L_go43
    s_waitcnt vmcnt(4)
    s_bitcmp1_b32 s90, 10
    s_cbranch_scc0 L_go43
    s_waitcnt vmcnt(3)
L_go43:
    buffer_load_dwordx4 v[68:71], v1, s[32:35], s36 offen offset:1024 nt
    v_and_b32_dpp v28, v241, v2 row_newbcast:10 row_mask:0xf bank_mask:0xf
    v_and_b32_dpp v29, v241, v3 row_newbcast:10 row_mask:0xf bank_mask:0xf
    v_and_b32_dpp v30, v241, v4 row_newbcast:10 row_mask:0xf bank_mask:0xf
    v_and_b32_dpp v31, v241, v5 row_newbcast:10 row_mask:0xf bank_mask:0xf
    s_nop 1
    v_mfma_f32_16x16x32_bf16 v[24:27], v[28:31], v[72:75], v[24:27]
    s_waitcnt vmcnt(5)
    s_bitcmp1_b32 s88, 11
    s_cbranch_scc0 L_go44
    s_waitcnt vmcnt(4)
    s_bitcmp1_b32 s90, 11
    s_cbranch_scc0 L_go44
    s_waitcnt vmcnt(3)
L_go44:
    buffer_load_dwordx4 v[72:75], v1, s[32:35], s36 offen offset:2048 nt
    v_and_b32_dpp v28, v241, v2 row_newbcast:14 row_mask:0xf bank_mask:0xf
    v_and_b32_dpp v29, v241, v3 row_newbcast:14 row_mask:0xf bank_mask:0xf
    v_and_b32_dpp v30, v241, v4 row_newbcast:14 row_mask:0xf bank_mask:0xf
    v_and_b32_dpp v31, v241, v5 row_newbcast:14 row_mask:0xf bank_mask:0xf
    s_nop 1
    v_mfma_f32_16x16x32_bf16 v[24:27], v[28:31], v[76:79], v[24:27]
    s_waitcnt vmcnt(5)
    s_bitcmp1_b32 s88, 12
    s_cbranch_scc0 L_go45
    s_waitcnt vmcnt(4)
    s_bitcmp1_b32 s90, 12
    s_cbranch_scc0 L_go45
    s_waitcnt vmcnt(3)
L_go45:
    buffer_load_dwordx4 v[76:79], v1, s[32:35], s36 offen offset:3072 nt
    s_add_u32 s36, s36, 0x20000
    s_and_b32 s36, s36, 0x7fffff
    s_or_b32 s36, s36, s38
    s_add_u32 s37, s37, 1
    v_mov_b32 v242, s37
    ds_write_b32 v244, v242 offset:14336
    s_cmp_eq_u32 s37, 64
    s_cselect_b32 s32, s8, s32
    s_cselect_b32 s33, s9, s33
    v_and_b32_dpp v28, v241, v2 row_newbcast:3 row_mask:0xf bank_mask:0xf
    v_and_b32_dpp v29, v241, v3 row_newbcast:3 row_mask:0xf bank_mask:0xf
    v_and_b32_dpp v30, v241, v4 row_newbcast:3 row_mask:0xf bank_mask:0xf
    v_and_b32_dpp v31, v241, v5 row_newbcast:3 row_mask:0xf bank_mask:0xf
    s_nop 1
    v_mfma_f32_16x16x32_bf16 v[24:27], v[28:31], v[80:83], v[24:27]
    s_waitcnt vmcnt(5)
    s_bitcmp1_b32 s88, 13
    s_cbranch_scc0 L_go46
    s_waitcnt vmcnt(4)
    s_bitcmp1_b32 s90, 13
    s_cbranch_scc0 L_go46
    s_waitcnt vmcnt(3)
L_go46:
    buffer_load_dwordx4 v[80:83], v1, s[32:35], s36 offen offset:0 nt
    v_and_b32_dpp v28, v241, v2 row_newbcast:7 row_mask:0xf bank_mask:0xf
    v_and_b32_dpp v29, v241, v3 row_newbcast:7 row_mask:0xf bank_mask:0xf
    v_and_b32_dpp v30, v241, v4 row_newbcast:7 row_mask:0xf bank_mask:0xf
    v_and_b32_dpp v31, v241, v5 row_newbcast:7 row_mask:0xf bank_mask:0xf
    s_nop 1
    v_mfma_f32_16x16x32_bf16 v[24:27], v[28:31], v[84:87], v[24:27]
    s_waitcnt vmcnt(5)
    s_bitcmp1_b32 s88, 14
    s_cbranch_scc0 L_go47
    s_waitcnt vmcnt(4)
    s_bitcmp1_b32 s90, 14
    s_cbranch_scc0 L_go47
    s_waitcnt vmcnt(3)
L_go47:
    buffer_load_dwordx4 v[84:87], v1, s[32:35], s36 offen offset:1024 nt
    v_and_b32_dpp v28, v241, v2 row_newbcast:11 row_mask:0xf bank_mask:0xf
    v_and_b32_dpp v29, v241, v3 row_newbcast:11 row_mask:0xf bank_mask:0xf
    v_and_b32_dpp v30, v241, v4 row_newbcast:11 row_mask:0xf bank_mask:0xf
    v_and_b32_dpp v31, v241, v5 row_newbcast:11 row_mask:0xf bank_mask:0xf
    s_nop 1
    v_mfma_f32_16x16x32_bf16 v[24:27], v[28:31], v[88:91], v[24:27]
    s_waitcnt vmcnt(5)
    s_bitcmp1_b32 s88, 15
    s_cbranch_scc0 L_go48
    s_waitcnt vmcnt(4)
    s_bitcmp1_b32 s90, 15
    s_cbranch_scc0 L_go48
    s_waitcnt vmcnt(3)
L_go48:
    buffer_load_dwordx4 v[88:91], v1, s[32:35], s36 offen offset:2048 nt
    v_and_b32_dpp v28, v241, v2 row_newbcast:15 row_mask:0xf bank_mask:0xf
    v_and_b32_dpp v29, v241, v3 row_newbcast:15 row_mask:0xf bank_mask:0xf
    v_and_b32_dpp v30, v241, v4 row_newbcast:15 row_mask:0xf bank_mask:0xf
    v_and_b32_dpp v31, v241, v5 row_newbcast:15 row_mask:0xf bank_mask:0xf
    s_nop 1
    v_mfma_f32_16x16x32_bf16 v[24:27], v[28:31], v[92:95], v[24:27]
    s_waitcnt lgkmcnt(0)
    v_cmp_le_i32 s[88:89], v246, v248
    v_cmp_le_i32 s[90:91], v246, v249
    v_fma_f32 v20, v245, s65, v23
    v_exp_f32 v20, v20
    s_nop 0
    v_cvt_pk_bf16_f32 v241, v20, v20
    s_waitcnt vmcnt(5)
    s_bitcmp1_b32 s88, 0
    s_cbranch_scc0 L_go49
    s_waitcnt vmcnt(4)
    s_bitcmp1_b32 s90, 0
    s_cbranch_scc0 L_go49
    s_waitcnt vmcnt(3)
L_go49:
    buffer_load_dwordx4 v[92:95], v1, s[32:35], s36 offen offset:3072 nt
    s_add_u32 s36, s36, 0x20000
    s_and_b32 s36, s36, 0x7fffff
    s_or_b32 s36, s36, s38
    s_add_u32 s37, s37, 1
    v_mov_b32 v242, s37
    ds_write_b32 v244, v242 offset:14336
    s_cmp_eq_u32 s37, 64
    s_cselect_b32 s32, s8, s32
    s_cselect_b32 s33, s9, s33
    v_and_b32_dpp v28, v241, v2 row_newbcast:0 row_mask:0xf bank_mask:0xf
    v_and_b32_dpp v29, v241, v3 row_newbcast:0 row_mask:0xf bank_mask:0xf
    v_and_b32_dpp v30, v241, v4 row_newbcast:0 row_mask:0xf bank_mask:0xf
    v_and_b32_dpp v31, v241, v5 row_newbcast:0 row_mask:0xf bank_mask:0xf
    s_nop 1
    v_mfma_f32_16x16x32_bf16 v[24:27], v[28:31], v[96:99], v[24:27]
    s_waitcnt vmcnt(5)
    s_bitcmp1_b32 s88, 1
    s_cbranch_scc0 L_go50
    s_waitcnt vmcnt(4)
    s_bitcmp1_b32 s90, 1
    s_cbranch_scc0 L_go50
    s_waitcnt vmcnt(3)
L_go50:
    buffer_load_dwordx4 v[96:99], v1, s[32:35], s36 offen offset:0 nt
    v_and_b32_dpp v28, v241, v2 row_newbcast:4 row_mask:0xf bank_mask:0xf
    v_and_b32_dpp v29, v241, v3 row_newbcast:4 row_mask:0xf bank_mask:0xf
    v_and_b32_dpp v30, v241, v4 row_newbcast:4 row_mask:0xf bank_mask:0xf
    v_and_b32_dpp v31, v241, v5 row_newbcast:4 row_mask:0xf bank_mask:0xf
    s_nop 1
    v_mfma_f32_16x16x32_bf16 v[24:27], v[28:31], v[100:103], v[24:27]
    s_waitcnt vmcnt(5)
    s_bitcmp1_b32 s88, 2
    s_cbranch_scc0 L_go51
    s_waitcnt vmcnt(4)
    s_bitcmp1_b32 s90, 2
    s_cbranch_scc0 L_go51
    s_waitcnt vmcnt(3)
L_go51:
    buffer_load_dwordx4 v[100:103], v1, s[32:35], s36 offen offset:1024 nt
    v_and_b32_dpp v28, v241, v2 row_newbcast:8 row_mask:0xf bank_mask:0xf
    v_and_b32_dpp v29, v241, v3 row_newbcast:8 row_mask:0xf bank_mask:0xf
    v_and_b32_dpp v30, v241, v4 row_newbcast:8 row_mask:0xf bank_mask:0xf
    v_and_b32_dpp v31, v241, v5 row_newbcast:8 row_mask:0xf bank_mask:0xf
    s_nop 1
    v_mfma_f32_16x16x32_bf16 v[24:27], v[28:31], v[104:107], v[24:27]
    s_waitcnt vmcnt(5)
    s_bitcmp1_b32 s88, 3
    s_cbranch_scc0 L_go52
    s_waitcnt vmcnt(4)
    s_bitcmp1_b32 s90, 3
    s_cbranch_scc0 L_go52
    s_waitcnt vmcnt(3)
L_go52:
    buffer_load_dwordx4 v[104:107], v1, s[32:35], s36 offen offset:2048 nt
    v_and_b32_dpp v28, v241, v2 row_newbcast:12 row_mask:0xf bank_mask:0xf
    v_and_b32_dpp v29, v241, v3 row_newbcast:12 row_mask:0xf bank_mask:0xf
    v_and_b32_dpp v30, v241, v4 row_newbcast:12 row_mask:0xf bank_mask:0xf
    v_and_b32_dpp v31, v241, v5 row_newbcast:12 row_mask:0xf bank_mask:0xf
    s_nop 1
    v_mfma_f32_16x16x32_bf16 v[24:27], v[28:31], v[108:111], v[24:27]
    s_waitcnt vmcnt(5)
    s_bitcmp1_b32 s88, 4
    s_cbranch_scc0 L_go53
    s_waitcnt vmcnt(4)
    s_bitcmp1_b32 s90, 4
    s_cbranch_scc0 L_go53
    s_waitcnt vmcnt(3)
L_go53:
    buffer_load_dwordx4 v[108:111], v1, s[32:35], s36 offen offset:3072 nt
    s_add_u32 s36, s36, 0x20000
    s_and_b32 s36, s36, 0x7fffff
    s_or_b32 s36, s36, s38
    s_add_u32 s37, s37, 1
    v_mov_b32 v242, s37
    ds_write_b32 v244, v242 offset:14336
    s_cmp_eq_u32 s37, 64
    s_cselect_b32 s32, s8, s32
    s_cselect_b32 s33, s9, s33
    v_and_b32_dpp v28, v241, v2 row_newbcast:1 row_mask:0xf bank_mask:0xf
    v_and_b32_dpp v29, v241, v3 row_newbcast:1 row_mask:0xf bank_mask:0xf
    v_and_b32_dpp v30, v241, v4 row_newbcast:1 row_mask:0xf bank_mask:0xf
    v_and_b32_dpp v31, v241, v5 row_newbcast:1 row_mask:0xf bank_mask:0xf
    s_nop 1
    v_mfma_f32_16x16x32_bf16 v[24:27], v[28:31], v[112:115], v[24:27]
    s_waitcnt vmcnt(5)
    s_bitcmp1_b32 s88, 5
    s_cbranch_scc0 L_go54
    s_waitcnt vmcnt(4)
    s_bitcmp1_b32 s90, 5
    s_cbranch_scc0 L_go54
    s_waitcnt vmcnt(3)
L_go54:
    buffer_load_dwordx4 v[112:115], v1, s[32:35], s36 offen offset:0 nt
    v_and_b32_dpp v28, v241, v2 row_newbcast:5 row_mask:0xf bank_mask:0xf
    v_and_b32_dpp v29, v241, v3 row_newbcast:5 row_mask:0xf bank_mask:0xf
    v_and_b32_dpp v30, v241, v4 row_newbcast:5 row_mask:0xf bank_mask:0xf
    v_and_b32_dpp v31, v241, v5 row_newbcast:5 row_mask:0xf bank_mask:0xf
    s_nop 1
    v_mfma_f32_16x16x32_bf16 v[24:27], v[28:31], v[116:119], v[24:27]
    s_waitcnt vmcnt(5)
    s_bitcmp1_b32 s88, 6
    s_cbranch_scc0 L_go55
    s_waitcnt vmcnt(4)
    s_bitcmp1_b32 s90, 6
    s_cbranch_scc0 L_go55
    s_waitcnt vmcnt(3)
L_go55:
    buffer_load_dwordx4 v[116:119], v1, s[32:35], s36 offen offset:1024 nt
    v_and_b32_dpp v28, v241, v2 row_newbcast:9 row_mask:0xf bank_mask:0xf
    v_and_b32_dpp v29, v241, v3 row_newbcast:9 row_mask:0xf bank_mask:0xf
    v_and_b32_dpp v30, v241, v4 row_newbcast:9 row_mask:0xf bank_mask:0xf
    v_and_b32_dpp v31, v241, v5 row_newbcast:9 row_mask:0xf bank_mask:0xf
    s_nop 1
    v_mfma_f32_16x16x32_bf16 v[24:27], v[28:31], v[120:123], v[24:27]
    s_waitcnt vmcnt(5)
    s_bitcmp1_b32 s88, 7
    s_cbranch_scc0 L_go56
    s_waitcnt vmcnt(4)
    s_bitcmp1_b32 s90, 7
    s_cbranch_scc0 L_go56
    s_waitcnt vmcnt(3)
L_go56:
    buffer_load_dwordx4 v[120:123], v1, s[32:35], s36 offen offset:2048 nt
    v_and_b32_dpp v28, v241, v2 row_newbcast:13 row_mask:0xf bank_mask:0xf
    v_and_b32_dpp v29, v241, v3 row_newbcast:13 row_mask:0xf bank_mask:0xf
    v_and_b32_dpp v30, v241, v4 row_newbcast:13 row_mask:0xf bank_mask:0xf
    v_and_b32_dpp v31, v241, v5 row_newbcast:13 row_mask:0xf bank_mask:0xf
    s_nop 1
    v_mfma_f32_16x16x32_bf16 v[24:27], v[28:31], v[124:127], v[24:27]
    s_waitcnt vmcnt(5)
    s_bitcmp1_b32 s88, 8
    s_cbranch_scc0 L_go57
    s_waitcnt vmcnt(4)
    s_bitcmp1_b32 s90, 8
    s_cbranch_scc0 L_go57
    s_waitcnt vmcnt(3)
L_go57:
    buffer_load_dwordx4 v[124:127], v1, s[32:35], s36 offen offset:3072 nt
    s_add_u32 s36, s36, 0x20000
    s_and_b32 s36, s36, 0x7fffff
    s_or_b32 s36, s36, s38
    s_add_u32 s37, s37, 1
    v_mov_b32 v242, s37
    ds_write_b32 v244, v242 offset:14336
    s_cmp_eq_u32 s37, 64
    s_cselect_b32 s32, s8, s32
    s_cselect_b32 s33, s9, s33
    v_and_b32_dpp v28, v241, v2 row_newbcast:2 row_mask:0xf bank_mask:0xf
    v_and_b32_dpp v29, v241, v3 row_newbcast:2 row_mask:0xf bank_mask:0xf
    v_and_b32_dpp v30, v241, v4 row_newbcast:2 row_mask:0xf bank_mask:0xf
    v_and_b32_dpp v31, v241, v5 row_newbcast:2 row_mask:0xf bank_mask:0xf
    s_nop 1
    v_mfma_f32_16x16x32_bf16 v[24:27], v[28:31], v[128:131], v[24:27]
    ds_read_u16_d16_hi v245, v22
    v_add_u32 v22, 128, v22
    ds_read_b32 v246, v247 offset:13312
    s_waitcnt vmcnt(5)
    s_bitcmp1_b32 s88, 9
    s_cbranch_scc0 L_go58
    s_waitcnt vmcnt(4)
    s_bitcmp1_b32 s90, 9
    s_cbranch_scc0 L_go58
    s_waitcnt vmcnt(3)
L_go58:
    buffer_load_dwordx4 v[128:131], v1, s[32:35], s36 offen offset:0 nt
    v_and_b32_dpp v28, v241, v2 row_newbcast:6 row_mask:0xf bank_mask:0xf
    v_and_b32_dpp v29, v241, v3 row_newbcast:6 row_mask:0xf bank_mask:0xf
    v_and_b32_dpp v30, v241, v4 row_newbcast:6 row_mask:0xf bank_mask:0xf
    v_and_b32_dpp v31, v241, v5 row_newbcast:6 row_mask:0xf bank_mask:0xf
    s_nop 1
    v_mfma_f32_16x16x32_bf16 v[24:27], v[28:31], v[132:135], v[24:27]
    s_waitcnt vmcnt(5)
    s_bitcmp1_b32 s88, 10
    s_cbranch_scc0 L_go59
    s_waitcnt vmcnt(4)
    s_bitcmp1_b32 s90, 10
    s_cbranch_scc0 L_go59
    s_waitcnt vmcnt(3)
L_go59:
    buffer_load_dwordx4 v[132:135], v1, s[32:35], s36 offen offset:1024 nt
    v_and_b32_dpp v28, v241, v2 row_newbcast:10 row_mask:0xf bank_mask:0xf
    v_and_b32_dpp v29, v241, v3 row_newbcast:10 row_mask:0xf bank_mask:0xf
    v_and_b32_dpp v30, v241, v4 row_newbcast:10 row_mask:0xf bank_mask:0xf
    v_and_b32_dpp v31, v241, v5 row_newbcast:10 row_mask:0xf bank_mask:0xf
    s_nop 1
    v_mfma_f32_16x16x32_bf16 v[24:27], v[28:31], v[136:139], v[24:27]
    s_waitcnt vmcnt(5)
    s_bitcmp1_b32 s88, 11
    s_cbranch_scc0 L_go60
    s_waitcnt vmcnt(4)
    s_bitcmp1_b32 s90, 11
    s_cbranch_scc0 L_go60
    s_waitcnt vmcnt(3)
L_go60:
    buffer_load_dwordx4 v[136:139], v1, s[32:35], s36 offen offset:2048 nt
    v_and_b32_dpp v28, v241, v2 row_newbcast:14 row_mask:0xf bank_mask:0xf
    v_and_b32_dpp v29, v241, v3 row_newbcast:14 row_mask:0xf bank_mask:0xf
    v_and_b32_dpp v30, v241, v4 row_newbcast:14 row_mask:0xf bank_mask:0xf
    v_and_b32_dpp v31, v241, v5 row_newbcast:14 row_mask:0xf bank_mask:0xf
    s_nop 1
    v_mfma_f32_16x16x32_bf16 v[24:27], v[28:31], v[140:143], v[24:27]
    s_waitcnt vmcnt(5)
    s_bitcmp1_b32 s88, 12
    s_cbranch_scc0 L_go61
    s_waitcnt vmcnt(4)
    s_bitcmp1_b32 s90, 12
    s_cbranch_scc0 L_go61
    s_waitcnt vmcnt(3)
L_go61:
    buffer_load_dwordx4 v[140:143], v1, s[32:35], s36 offen offset:3072 nt
    s_add_u32 s36, s36, 0x20000
    s_and_b32 s36, s36, 0x7fffff
    s_or_b32 s36, s36, s38
    s_add_u32 s37, s37, 1
    v_mov_b32 v242, s37
    ds_write_b32 v244, v242 offset:14336
    s_cmp_eq_u32 s37, 64
    s_cselect_b32 s32, s8, s32
    s_cselect_b32 s33, s9, s33
    v_and_b32_dpp v28, v241, v2 row_newbcast:3 row_mask:0xf bank_mask:0xf
    v_and_b32_dpp v29, v241, v3 row_newbcast:3 row_mask:0xf bank_mask:0xf
    v_and_b32_dpp v30, v241, v4 row_newbcast:3 row_mask:0xf bank_mask:0xf
    v_and_b32_dpp v31, v241, v5 row_newbcast:3 row_mask:0xf bank_mask:0xf
    s_nop 1
    v_mfma_f32_16x16x32_bf16 v[24:27], v[28:31], v[144:147], v[24:27]
    s_waitcnt vmcnt(5)
    s_bitcmp1_b32 s88, 13
    s_cbranch_scc0 L_go62
    s_waitcnt vmcnt(4)
    s_bitcmp1_b32 s90, 13
    s_cbranch_scc0 L_go62
    s_waitcnt vmcnt(3)
L_go62:
    buffer_load_dwordx4 v[144:147], v1, s[32:35], s36 offen offset:0 nt
    v_and_b32_dpp v28, v241, v2 row_newbcast:7 row_mask:0xf bank_mask:0xf
    v_and_b32_dpp v29, v241, v3 row_newbcast:7 row_mask:0xf bank_mask:0xf
    v_and_b32_dpp v30, v241, v4 row_newbcast:7 row_mask:0xf bank_mask:0xf
    v_and_b32_dpp v31, v241, v5 row_newbcast:7 row_mask:0xf bank_mask:0xf
    s_nop 1
    v_mfma_f32_16x16x32_bf16 v[24:27], v[28:31], v[148:151], v[24:27]
    s_waitcnt vmcnt(5)
    s_bitcmp1_b32 s88, 14
    s_cbranch_scc0 L_go63
    s_waitcnt vmcnt(4)
    s_bitcmp1_b32 s90, 14
    s_cbranch_scc0 L_go63
    s_waitcnt vmcnt(3)
L_go63:
    buffer_load_dwordx4 v[148:151], v1, s[32:35], s36 offen offset:1024 nt
    v_and_b32_dpp v28, v241, v2 row_newbcast:11 row_mask:0xf bank_mask:0xf
    v_and_b32_dpp v29, v241, v3 row_newbcast:11 row_mask:0xf bank_mask:0xf
    v_and_b32_dpp v30, v241, v4 row_newbcast:11 row_mask:0xf bank_mask:0xf
    v_and_b32_dpp v31, v241, v5 row_newbcast:11 row_mask:0xf bank_mask:0xf
    s_nop 1
    v_mfma_f32_16x16x32_bf16 v[24:27], v[28:31], v[152:155], v[24:27]
    s_waitcnt vmcnt(5)
    s_bitcmp1_b32 s88, 15
    s_cbranch_scc0 L_go64
    s_waitcnt vmcnt(4)
    s_bitcmp1_b32 s90, 15
    s_cbranch_scc0 L_go64
    s_waitcnt vmcnt(3)
L_go64:
    buffer_load_dwordx4 v[152:155], v1, s[32:35], s36 offen offset:2048 nt
    v_and_b32_dpp v28, v241, v2 row_newbcast:15 row_mask:0xf bank_mask:0xf
    v_and_b32_dpp v29, v241, v3 row_newbcast:15 row_mask:0xf bank_mask:0xf
    v_and_b32_dpp v30, v241, v4 row_newbcast:15 row_mask:0xf bank_mask:0xf
    v_and_b32_dpp v31, v241, v5 row_newbcast:15 row_mask:0xf bank_mask:0xf
    s_nop 1
    v_mfma_f32_16x16x32_bf16 v[24:27], v[28:31], v[156:159], v[24:27]
    s_add_u32 s39, s39, 1
    s_cmp_lt_u32 s39, 6
    s_cbranch_scc1 L_vloop
    s_cmp_eq_u32 s39, 6
    s_cbranch_scc0 L_vlast
    v_mov_b32 v20, 10772
L_scale_wait:
    ds_read_b32 v21, v20
    s_waitcnt lgkmcnt(0)
    v_readfirstlane_b32 s58, v21
    s_cmp_eq_u32 s58, 1
    s_cbranch_scc1 L_scale_ok
    s_sleep 2
    s_add_u32 s78, s78, 1
    s_cmp_lt_u32 s78, 0x200000
    s_cbranch_scc1 L_scale_wait
L_scale_ok:
    ds_read_b32 v10, v240 offset:10784
    ds_read_b32 v21, v20 offset:28
    v_lshrrev_b32 v181, 4, v0
    v_mul_u32_u24 v181, 20, v181
    ds_read_b32 v208, v181 offset:10816
    ds_read_b32 v209, v181 offset:10820
    ds_read_b32 v210, v181 offset:10824
    ds_read_b32 v211, v181 offset:10828
    ds_read_b32 v212, v181 offset:10832
    s_waitcnt lgkmcnt(0)
    v_readfirstlane_b32 s57, v21
    s_branch L_vloop
L_vlast:
    s_waitcnt lgkmcnt(0)
    v_cmp_le_i32 s[88:89], v246, v248
    v_cmp_le_i32 s[90:91], v246, v249
    v_fma_f32 v20, v245, s65, v23
    v_exp_f32 v20, v20
    s_nop 0
    v_cvt_pk_bf16_f32 v241, v20, v20
    s_waitcnt vmcnt(5)
    s_bitcmp1_b32 s88, 0
    s_cbranch_scc0 L_go65
    s_waitcnt vmcnt(4)
    s_bitcmp1_b32 s90, 0
    s_cbranch_scc0 L_go65
    s_waitcnt vmcnt(3)
L_go65:
    buffer_load_dwordx4 v[156:159], v1, s[32:35], s36 offen offset:3072 nt
    s_add_u32 s36, s36, 0x20000
    s_and_b32 s36, s36, 0x7fffff
    s_or_b32 s36, s36, s38
    s_add_u32 s37, s37, 1
    v_mov_b32 v242, s37
    ds_write_b32 v244, v242 offset:14336
    s_cmp_eq_u32 s37, 64
    s_cselect_b32 s32, s8, s32
    s_cselect_b32 s33, s9, s33
    v_and_b32_dpp v28, v241, v2 row_newbcast:0 row_mask:0xf bank_mask:0xf
    v_and_b32_dpp v29, v241, v3 row_newbcast:0 row_mask:0xf bank_mask:0xf
    v_and_b32_dpp v30, v241, v4 row_newbcast:0 row_mask:0xf bank_mask:0xf
    v_and_b32_dpp v31, v241, v5 row_newbcast:0 row_mask:0xf bank_mask:0xf
    s_nop 1
    v_mfma_f32_16x16x32_bf16 v[24:27], v[28:31], v[32:35], v[24:27]
    s_waitcnt vmcnt(30)
    v_and_b32_dpp v28, v241, v2 row_newbcast:4 row_mask:0xf bank_mask:0xf
    v_and_b32_dpp v29, v241, v3 row_newbcast:4 row_mask:0xf bank_mask:0xf
    v_and_b32_dpp v30, v241, v4 row_newbcast:4 row_mask:0xf bank_mask:0xf
    v_and_b32_dpp v31, v241, v5 row_newbcast:4 row_mask:0xf bank_mask:0xf
    s_nop 1
    v_mfma_f32_16x16x32_bf16 v[24:27], v[28:31], v[36:39], v[24:27]
    s_waitcnt vmcnt(29)
    v_and_b32_dpp v28, v241, v2 row_newbcast:8 row_mask:0xf bank_mask:0xf
    v_and_b32_dpp v29, v241, v3 row_newbcast:8 row_mask:0xf bank_mask:0xf
    v_and_b32_dpp v30, v241, v4 row_newbcast:8 row_mask:0xf bank_mask:0xf
    v_and_b32_dpp v31, v241, v5 row_newbcast:8 row_mask:0xf bank_mask:0xf
    s_nop 1
    v_mfma_f32_16x16x32_bf16 v[24:27], v[28:31], v[40:43], v[24:27]
    s_waitcnt vmcnt(28)
    v_and_b32_dpp v28, v241, v2 row_newbcast:12 row_mask:0xf bank_mask:0xf
    v_and_b32_dpp v29, v241, v3 row_newbcast:12 row_mask:0xf bank_mask:0xf
    v_and_b32_dpp v30, v241, v4 row_newbcast:12 row_mask:0xf bank_mask:0xf
    v_and_b32_dpp v31, v241, v5 row_newbcast:12 row_mask:0xf bank_mask:0xf
    s_nop 1
    v_mfma_f32_16x16x32_bf16 v[24:27], v[28:31], v[44:47], v[24:27]
    s_waitcnt vmcnt(27)
    buffer_load_dwordx4 v[188:191], v186, s[40:43], s94 offen offset:0 nt
    v_and_b32_dpp v28, v241, v2 row_newbcast:1 row_mask:0xf bank_mask:0xf
    v_and_b32_dpp v29, v241, v3 row_newbcast:1 row_mask:0xf bank_mask:0xf
    v_and_b32_dpp v30, v241, v4 row_newbcast:1 row_mask:0xf bank_mask:0xf
    v_and_b32_dpp v31, v241, v5 row_newbcast:1 row_mask:0xf bank_mask:0xf
    s_nop 1
    v_mfma_f32_16x16x32_bf16 v[24:27], v[28:31], v[48:51], v[24:27]
    s_waitcnt vmcnt(27)
    v_and_b32_dpp v28, v241, v2 row_newbcast:5 row_mask:0xf bank_mask:0xf
    v_and_b32_dpp v29, v241, v3 row_newbcast:5 row_mask:0xf bank_mask:0xf
    v_and_b32_dpp v30, v241, v4 row_newbcast:5 row_mask:0xf bank_mask:0xf
    v_and_b32_dpp v31, v241, v5 row_newbcast:5 row_mask:0xf bank_mask:0xf
    s_nop 1
    v_mfma_f32_16x16x32_bf16 v[24:27], v[28:31], v[52:55], v[24:27]
    s_waitcnt vmcnt(26)
    v_and_b32_dpp v28, v241, v2 row_newbcast:9 row_mask:0xf bank_mask:0xf
    v_and_b32_dpp v29, v241, v3 row_newbcast:9 row_mask:0xf bank_mask:0xf
    v_and_b32_dpp v30, v241, v4 row_newbcast:9 row_mask:0xf bank_mask:0xf
    v_and_b32_dpp v31, v241, v5 row_newbcast:9 row_mask:0xf bank_mask:0xf
    s_nop 1
    v_mfma_f32_16x16x32_bf16 v[24:27], v[28:31], v[56:59], v[24:27]
    s_waitcnt vmcnt(25)
    v_and_b32_dpp v28, v241, v2 row_newbcast:13 row_mask:0xf bank_mask:0xf
    v_and_b32_dpp v29, v241, v3 row_newbcast:13 row_mask:0xf bank_mask:0xf
    v_and_b32_dpp v30, v241, v4 row_newbcast:13 row_mask:0xf bank_mask:0xf
    v_and_b32_dpp v31, v241, v5 row_newbcast:13 row_mask:0xf bank_mask:0xf
    s_nop 1
    v_mfma_f32_16x16x32_bf16 v[24:27], v[28:31], v[60:63], v[24:27]
    s_waitcnt vmcnt(24)
    buffer_load_dwordx4 v[192:195], v186, s[40:43], s94 offen offset:1152 nt
    v_and_b32_dpp v28, v241, v2 row_newbcast:2 row_mask:0xf bank_mask:0xf
    v_and_b32_dpp v29, v241, v3 row_newbcast:2 row_mask:0xf bank_mask:0xf
    v_and_b32_dpp v30, v241, v4 row_newbcast:2 row_mask:0xf bank_mask:0xf
    v_and_b32_dpp v31, v241, v5 row_newbcast:2 row_mask:0xf bank_mask:0xf
    s_nop 1
    v_mfma_f32_16x16x32_bf16 v[24:27], v[28:31], v[64:67], v[24:27]
    ds_read_u16_d16_hi v245, v22
    v_add_u32 v22, 128, v22
    s_waitcnt vmcnt(24)
    v_and_b32_dpp v28, v241, v2 row_newbcast:6 row_mask:0xf bank_mask:0xf
    v_and_b32_dpp v29, v241, v3 row_newbcast:6 row_mask:0xf bank_mask:0xf
    v_and_b32_dpp v30, v241, v4 row_newbcast:6 row_mask:0xf bank_mask:0xf
    v_and_b32_dpp v31, v241, v5 row_newbcast:6 row_mask:0xf bank_mask:0xf
    s_nop 1
    v_mfma_f32_16x16x32_bf16 v[24:27], v[28:31], v[68:71], v[24:27]
    s_waitcnt vmcnt(23)
    v_and_b32_dpp v28, v241, v2 row_newbcast:10 row_mask:0xf bank_mask:0xf
    v_and_b32_dpp v29, v241, v3 row_newbcast:10 row_mask:0xf bank_mask:0xf
    v_and_b32_dpp v30, v241, v4 row_newbcast:10 row_mask:0xf bank_mask:0xf
    v_and_b32_dpp v31, v241, v5 row_newbcast:10 row_mask:0xf bank_mask:0xf
    s_nop 1
    v_mfma_f32_16x16x32_bf16 v[24:27], v[28:31], v[72:75], v[24:27]
    s_waitcnt vmcnt(22)
    v_and_b32_dpp v28, v241, v2 row_newbcast:14 row_mask:0xf bank_mask:0xf
    v_and_b32_dpp v29, v241, v3 row_newbcast:14 row_mask:0xf bank_mask:0xf
    v_and_b32_dpp v30, v241, v4 row_newbcast:14 row_mask:0xf bank_mask:0xf
    v_and_b32_dpp v31, v241, v5 row_newbcast:14 row_mask:0xf bank_mask:0xf
    s_nop 1
    v_mfma_f32_16x16x32_bf16 v[24:27], v[28:31], v[76:79], v[24:27]
    s_waitcnt vmcnt(21)
    buffer_load_dwordx4 v[196:199], v186, s[40:43], s94 offen offset:2304 nt
    v_and_b32_dpp v28, v241, v2 row_newbcast:3 row_mask:0xf bank_mask:0xf
    v_and_b32_dpp v29, v241, v3 row_newbcast:3 row_mask:0xf bank_mask:0xf
    v_and_b32_dpp v30, v241, v4 row_newbcast:3 row_mask:0xf bank_mask:0xf
    v_and_b32_dpp v31, v241, v5 row_newbcast:3 row_mask:0xf bank_mask:0xf
    s_nop 1
    v_mfma_f32_16x16x32_bf16 v[24:27], v[28:31], v[80:83], v[24:27]
    s_waitcnt vmcnt(21)
    v_and_b32_dpp v28, v241, v2 row_newbcast:7 row_mask:0xf bank_mask:0xf
    v_and_b32_dpp v29, v241, v3 row_newbcast:7 row_mask:0xf bank_mask:0xf
    v_and_b32_dpp v30, v241, v4 row_newbcast:7 row_mask:0xf bank_mask:0xf
    v_and_b32_dpp v31, v241, v5 row_newbcast:7 row_mask:0xf bank_mask:0xf
    s_nop 1
    v_mfma_f32_16x16x32_bf16 v[24:27], v[28:31], v[84:87], v[24:27]
    s_waitcnt vmcnt(20)
    v_and_b32_dpp v28, v241, v2 row_newbcast:11 row_mask:0xf bank_mask:0xf
    v_and_b32_dpp v29, v241, v3 row_newbcast:11 row_mask:0xf bank_mask:0xf
    v_and_b32_dpp v30, v241, v4 row_newbcast:11 row_mask:0xf bank_mask:0xf
    v_and_b32_dpp v31, v241, v5 row_newbcast:11 row_mask:0xf bank_mask:0xf
    s_nop 1
    v_mfma_f32_16x16x32_bf16 v[24:27], v[28:31], v[88:91], v[24:27]
    s_waitcnt vmcnt(19)
    v_and_b32_dpp v28, v241, v2 row_newbcast:15 row_mask:0xf bank_mask:0xf
    v_and_b32_dpp v29, v241, v3 row_newbcast:15 row_mask:0xf bank_mask:0xf
    v_and_b32_dpp v30, v241, v4 row_newbcast:15 row_mask:0xf bank_mask:0xf
    v_and_b32_dpp v31, v241, v5 row_newbcast:15 row_mask:0xf bank_mask:0xf
    s_nop 1
    v_mfma_f32_16x16x32_bf16 v[24:27], v[28:31], v[92:95], v[24:27]
    s_waitcnt lgkmcnt(0)
    v_cmp_le_i32 s[88:89], v246, v248
    v_cmp_le_i32 s[90:91], v246, v249
    v_fma_f32 v20, v245, s65, v23
    v_exp_f32 v20, v20
    s_nop 0
    v_cvt_pk_bf16_f32 v241, v20, v20
    s_waitcnt vmcnt(18)
    buffer_load_dwordx4 v[200:203], v186, s[40:43], s94 offen offset:3456 nt
    v_and_b32_dpp v28, v241, v2 row_newbcast:0 row_mask:0xf bank_mask:0xf
    v_and_b32_dpp v29, v241, v3 row_newbcast:0 row_mask:0xf bank_mask:0xf
    v_and_b32_dpp v30, v241, v4 row_newbcast:0 row_mask:0xf bank_mask:0xf
    v_and_b32_dpp v31, v241, v5 row_newbcast:0 row_mask:0xf bank_mask:0xf
    s_nop 1
    v_mfma_f32_16x16x32_bf16 v[24:27], v[28:31], v[96:99], v[24:27]
    s_waitcnt vmcnt(18)
    v_and_b32_dpp v28, v241, v2 row_newbcast:4 row_mask:0xf bank_mask:0xf
    v_and_b32_dpp v29, v241, v3 row_newbcast:4 row_mask:0xf bank_mask:0xf
    v_and_b32_dpp v30, v241, v4 row_newbcast:4 row_mask:0xf bank_mask:0xf
    v_and_b32_dpp v31, v241, v5 row_newbcast:4 row_mask:0xf bank_mask:0xf
    s_nop 1
    v_mfma_f32_16x16x32_bf16 v[24:27], v[28:31], v[100:103], v[24:27]
    v_mov_b32 v22, 10776
    v_mov_b32 v19, 1
    s_waitcnt vmcnt(17)
    v_and_b32_dpp v28, v241, v2 row_newbcast:8 row_mask:0xf bank_mask:0xf
    v_and_b32_dpp v29, v241, v3 row_newbcast:8 row_mask:0xf bank_mask:0xf
    v_and_b32_dpp v30, v241, v4 row_newbcast:8 row_mask:0xf bank_mask:0xf
    v_and_b32_dpp v31, v241, v5 row_newbcast:8 row_mask:0xf bank_mask:0xf
    s_nop 1
    v_mfma_f32_16x16x32_bf16 v[24:27], v[28:31], v[104:107], v[24:27]
    s_waitcnt vmcnt(16)
    v_and_b32_dpp v28, v241, v2 row_newbcast:12 row_mask:0xf bank_mask:0xf
    v_and_b32_dpp v29, v241, v3 row_newbcast:12 row_mask:0xf bank_mask:0xf
    v_and_b32_dpp v30, v241, v4 row_newbcast:12 row_mask:0xf bank_mask:0xf
    v_and_b32_dpp v31, v241, v5 row_newbcast:12 row_mask:0xf bank_mask:0xf
    s_nop 1
    v_mfma_f32_16x16x32_bf16 v[24:27], v[28:31], v[108:111], v[24:27]
    s_waitcnt vmcnt(15)
    buffer_load_dwordx4 v[204:207], v186, s[40:43], s95 offen offset:0 nt
    v_and_b32_dpp v28, v241, v2 row_newbcast:1 row_mask:0xf bank_mask:0xf
    v_and_b32_dpp v29, v241, v3 row_newbcast:1 row_mask:0xf bank_mask:0xf
    v_and_b32_dpp v30, v241, v4 row_newbcast:1 row_mask:0xf bank_mask:0xf
    v_and_b32_dpp v31, v241, v5 row_newbcast:1 row_mask:0xf bank_mask:0xf
    s_nop 1
    v_mfma_f32_16x16x32_bf16 v[24:27], v[28:31], v[112:115], v[24:27]
    s_waitcnt vmcnt(15)
    v_and_b32_dpp v28, v241, v2 row_newbcast:5 row_mask:0xf bank_mask:0xf
    v_and_b32_dpp v29, v241, v3 row_newbcast:5 row_mask:0xf bank_mask:0xf
    v_and_b32_dpp v30, v241, v4 row_newbcast:5 row_mask:0xf bank_mask:0xf
    v_and_b32_dpp v31, v241, v5 row_newbcast:5 row_mask:0xf bank_mask:0xf
    s_nop 1
    v_mfma_f32_16x16x32_bf16 v[24:27], v[28:31], v[116:119], v[24:27]
    s_waitcnt vmcnt(14)
    v_and_b32_dpp v28, v241, v2 row_newbcast:9 row_mask:0xf bank_mask:0xf
    v_and_b32_dpp v29, v241, v3 row_newbcast:9 row_mask:0xf bank_mask:0xf
    v_and_b32_dpp v30, v241, v4 row_newbcast:9 row_mask:0xf bank_mask:0xf
    v_and_b32_dpp v31, v241, v5 row_newbcast:9 row_mask:0xf bank_mask:0xf
    s_nop 1
    v_mfma_f32_16x16x32_bf16 v[24:27], v[28:31], v[120:123], v[24:27]
    s_waitcnt vmcnt(13)
    v_and_b32_dpp v28, v241, v2 row_newbcast:13 row_mask:0xf bank_mask:0xf
    v_and_b32_dpp v29, v241, v3 row_newbcast:13 row_mask:0xf bank_mask:0xf
    v_and_b32_dpp v30, v241, v4 row_newbcast:13 row_mask:0xf bank_mask:0xf
    v_and_b32_dpp v31, v241, v5 row_newbcast:13 row_mask:0xf bank_mask:0xf
    s_nop 1
    v_mfma_f32_16x16x32_bf16 v[24:27], v[28:31], v[124:127], v[24:27]
    s_waitcnt vmcnt(12)
    buffer_load_dwordx4 v[160:163], v185, s[44:47], s93 offen offset:0 nt
    v_and_b32_dpp v28, v241, v2 row_newbcast:2 row_mask:0xf bank_mask:0xf
    v_and_b32_dpp v29, v241, v3 row_newbcast:2 row_mask:0xf bank_mask:0xf
    v_and_b32_dpp v30, v241, v4 row_newbcast:2 row_mask:0xf bank_mask:0xf
    v_and_b32_dpp v31, v241, v5 row_newbcast:2 row_mask:0xf bank_mask:0xf
    s_nop 1
    v_mfma_f32_16x16x32_bf16 v[24:27], v[28:31], v[128:131], v[24:27]
    s_waitcnt vmcnt(12)
    v_and_b32_dpp v28, v241, v2 row_newbcast:6 row_mask:0xf bank_mask:0xf
    v_and_b32_dpp v29, v241, v3 row_newbcast:6 row_mask:0xf bank_mask:0xf
    v_and_b32_dpp v30, v241, v4 row_newbcast:6 row_mask:0xf bank_mask:0xf
    v_and_b32_dpp v31, v241, v5 row_newbcast:6 row_mask:0xf bank_mask:0xf
    s_nop 1
    v_mfma_f32_16x16x32_bf16 v[24:27], v[28:31], v[132:135], v[24:27]
    s_waitcnt vmcnt(11)
    buffer_load_dwordx4 v[164:167], v185, s[44:47], s93 offen offset:1152 nt
    v_and_b32_dpp v28, v241, v2 row_newbcast:10 row_mask:0xf bank_mask:0xf
    v_and_b32_dpp v29, v241, v3 row_newbcast:10 row_mask:0xf bank_mask:0xf
    v_and_b32_dpp v30, v241, v4 row_newbcast:10 row_mask:0xf bank_mask:0xf
    v_and_b32_dpp v31, v241, v5 row_newbcast:10 row_mask:0xf bank_mask:0xf
    s_nop 1
    v_mfma_f32_16x16x32_bf16 v[24:27], v[28:31], v[136:139], v[24:27]
    s_waitcnt vmcnt(11)
    buffer_load_dwordx4 v[168:171], v185, s[44:47], s93 offen offset:2304 nt
    v_and_b32_dpp v28, v241, v2 row_newbcast:14 row_mask:0xf bank_mask:0xf
    v_and_b32_dpp v29, v241, v3 row_newbcast:14 row_mask:0xf bank_mask:0xf
    v_and_b32_dpp v30, v241, v4 row_newbcast:14 row_mask:0xf bank_mask:0xf
    v_and_b32_dpp v31, v241, v5 row_newbcast:14 row_mask:0xf bank_mask:0xf
    s_nop 1
    v_mfma_f32_16x16x32_bf16 v[24:27], v[28:31], v[140:143], v[24:27]
    s_waitcnt vmcnt(11)
    buffer_load_dwordx4 v[172:175], v185, s[44:47], s93 offen offset:3456 nt
    v_and_b32_dpp v28, v241, v2 row_newbcast:3 row_mask:0xf bank_mask:0xf
    v_and_b32_dpp v29, v241, v3 row_newbcast:3 row_mask:0xf bank_mask:0xf
    v_and_b32_dpp v30, v241, v4 row_newbcast:3 row_mask:0xf bank_mask:0xf
    v_and_b32_dpp v31, v241, v5 row_newbcast:3 row_mask:0xf bank_mask:0xf
    s_nop 1
    v_mfma_f32_16x16x32_bf16 v[24:27], v[28:31], v[144:147], v[24:27]
    s_waitcnt vmcnt(11)
    v_and_b32_dpp v28, v241, v2 row_newbcast:7 row_mask:0xf bank_mask:0xf
    v_and_b32_dpp v29, v241, v3 row_newbcast:7 row_mask:0xf bank_mask:0xf
    v_and_b32_dpp v30, v241, v4 row_newbcast:7 row_mask:0xf bank_mask:0xf
    v_and_b32_dpp v31, v241, v5 row_newbcast:7 row_mask:0xf bank_mask:0xf
    s_nop 1
    v_mfma_f32_16x16x32_bf16 v[24:27], v[28:31], v[148:151], v[24:27]
    s_waitcnt vmcnt(10)
    v_and_b32_dpp v28, v241, v2 row_newbcast:11 row_mask:0xf bank_mask:0xf
    v_and_b32_dpp v29, v241, v3 row_newbcast:11 row_mask:0xf bank_mask:0xf
    v_and_b32_dpp v30, v241, v4 row_newbcast:11 row_mask:0xf bank_mask:0xf
    v_and_b32_dpp v31, v241, v5 row_newbcast:11 row_mask:0xf bank_mask:0xf
    s_nop 1
    v_mfma_f32_16x16x32_bf16 v[24:27], v[28:31], v[152:155], v[24:27]
    s_waitcnt vmcnt(9)
    s_mov_b64 exec, 1
    ds_add_rtn_u32 v21, v22, v19
    s_mov_b64 exec, -1
    v_and_b32_dpp v28, v241, v2 row_newbcast:15 row_mask:0xf bank_mask:0xf
    v_and_b32_dpp v29, v241, v3 row_newbcast:15 row_mask:0xf bank_mask:0xf
    v_and_b32_dpp v30, v241, v4 row_newbcast:15 row_mask:0xf bank_mask:0xf
    v_and_b32_dpp v31, v241, v5 row_newbcast:15 row_mask:0xf bank_mask:0xf
    s_nop 1
    v_mfma_f32_16x16x32_bf16 v[24:27], v[28:31], v[156:159], v[24:27]
    s_mov_b32 exec_hi, 0
    s_nop 6
    v_mul_f32 v24, v10, v24
    v_mul_f32 v25, v10, v25
    v_mul_f32 v26, v10, v26
    v_mul_f32 v27, v10, v27
    v_bfi_b32 v24, 15, s84, v24
    v_bfi_b32 v25, 15, s85, v25
    v_bfi_b32 v26, 15, s86, v26
    v_bfi_b32 v27, 15, s87, v27
    s_cmp_eq_u32 s57, 1
    s_cbranch_scc1 L_near66
    buffer_store_dwordx4 v[24:27], v243, s[48:51], s69 offen sc1
    s_branch L_sent66
L_near66:
    buffer_store_dwordx4 v[24:27], v243, s[48:51], s69 offen
L_sent66:
    s_mov_b64 exec, -1
    s_waitcnt vmcnt(5)
    v_and_b32 v68, v208, v2
    v_and_b32 v69, v208, v3
    v_and_b32 v70, v208, v4
    v_and_b32 v71, v208, v5
    v_and_b32 v72, v209, v2
    v_and_b32 v73, v209, v3
    v_and_b32 v74, v209, v4
    v_and_b32 v75, v209, v5
    v_mfma_f32_16x16x32_bf16 v[176:179], v[68:71], v[188:191], 0
    v_and_b32 v68, v210, v2
    v_and_b32 v69, v210, v3
    v_and_b32 v70, v210, v4
    v_and_b32 v71, v210, v5
    v_mfma_f32_16x16x32_bf16 v[176:179], v[72:75], v[192:195], v[176:179]
    v_and_b32 v72, v211, v2
    v_and_b32 v73, v211, v3
    v_and_b32 v74, v211, v4
    v_and_b32 v75, v211, v5
    v_mfma_f32_16x16x32_bf16 v[176:179], v[68:71], v[196:199], v[176:179]
    v_and_b32 v68, v212, v2
    v_and_b32 v69, v212, v3
    v_and_b32 v70, v212, v4
    v_and_b32 v71, v212, v5
    v_mfma_f32_16x16x32_bf16 v[176:179], v[72:75], v[200:203], v[176:179]
    s_nop 0
    v_mfma_f32_16x16x32_bf16 v[176:179], v[68:71], v[204:207], v[176:179]
    s_waitcnt lgkmcnt(0)
    v_readfirstlane_b32 s58, v21
    s_cmp_eq_u32 s58, 3
    s_cbranch_scc1 L_peers_ok
    v_mov_b32 v20, 10776
L_peers_wait:
    ds_read_b32 v21, v20
    s_waitcnt lgkmcnt(0)
    v_readfirstlane_b32 s58, v21
    s_cmp_eq_u32 s58, 4
    s_cbranch_scc1 L_peers_ok
    s_sleep 1
    s_add_u32 s78, s78, 1
    s_cmp_lt_u32 s78, 0x200000
    s_cbranch_scc1 L_peers_wait
L_peers_ok:
L_s_owait:
    buffer_load_dwordx4 v[60:63], v182, s[48:51], s79 offen sc1
    buffer_load_dwordx4 v[64:67], v182, s[48:51], s79 offen offset:1024 sc1
    s_waitcnt vmcnt(0)
    v_xor_b32 v68, s84, v60
    v_xor_b32 v69, s85, v61
    v_xor_b32 v70, s86, v62
    v_xor_b32 v71, s87, v63
    v_or3_b32 v68, v68, v69, v70
    v_or_b32 v20, v68, v71
    v_xor_b32 v68, s84, v64
    v_xor_b32 v69, s85, v65
    v_xor_b32 v70, s86, v66
    v_xor_b32 v71, s87, v67
    v_or3_b32 v68, v68, v69, v70
    v_or3_b32 v20, v20, v68, v71
    v_and_b32 v20, 15, v20
    v_cmp_ne_u32 vcc, 0, v20
    s_or_b32 vcc_lo, vcc_lo, vcc_hi
    s_lshr_b32 s58, vcc_lo, 16
    s_or_b32 s58, s58, vcc_lo
    s_and_b32 s58, s58, 0xffff
    s_cbranch_scc0 L_s_odone
    s_mul_i32 exec_lo, s58, 0x10001
    s_mov_b32 exec_hi, exec_lo
    s_add_u32 s78, s78, 1
    s_cmp_lt_u32 s78, 0x200000
    s_cbranch_scc1 L_s_owait
L_s_odone:
    s_mov_b64 exec, -1
    v_and_b32 v60, -16, v60
    v_and_b32 v61, -16, v61
    v_and_b32 v62, -16, v62
    v_and_b32 v63, -16, v63
    v_and_b32 v64, -16, v64
    v_and_b32 v65, -16, v65
    v_and_b32 v66, -16, v66
    v_and_b32 v67, -16, v67
    v_add_f32 v60, v60, v64
    v_add_f32 v61, v61, v65
    v_add_f32 v62, v62, v66
    v_add_f32 v63, v63, v67
    v_add_f32_dpp v60, v60, v60 row_ror:8 row_mask:0xf bank_mask:0xf
    v_add_f32_dpp v61, v61, v61 row_ror:8 row_mask:0xf bank_mask:0xf
    v_add_f32_dpp v62, v62, v62 row_ror:8 row_mask:0xf bank_mask:0xf
    v_add_f32_dpp v63, v63, v63 row_ror:8 row_mask:0xf bank_mask:0xf
    v_add_f32_dpp v60, v60, v60 row_ror:4 row_mask:0xf bank_mask:0xf
    v_add_f32_dpp v61, v61, v61 row_ror:4 row_mask:0xf bank_mask:0xf
    v_add_f32_dpp v62, v62, v62 row_ror:4 row_mask:0xf bank_mask:0xf
    v_add_f32_dpp v63, v63, v63 row_ror:4 row_mask:0xf bank_mask:0xf
    v_add_f32_dpp v60, v60, v60 row_ror:2 row_mask:0xf bank_mask:0xf
    v_add_f32_dpp v61, v61, v61 row_ror:2 row_mask:0xf bank_mask:0xf
    v_add_f32_dpp v62, v62, v62 row_ror:2 row_mask:0xf bank_mask:0xf
    v_add_f32_dpp v63, v63, v63 row_ror:2 row_mask:0xf bank_mask:0xf
    v_add_f32_dpp v60, v60, v60 row_ror:1 row_mask:0xf bank_mask:0xf
    v_add_f32_dpp v61, v61, v61 row_ror:1 row_mask:0xf bank_mask:0xf
    v_add_f32_dpp v62, v62, v62 row_ror:1 row_mask:0xf bank_mask:0xf
    v_add_f32_dpp v63, v63, v63 row_ror:1 row_mask:0xf bank_mask:0xf
    v_cvt_pk_bf16_f32 v60, v60, v60
    v_cvt_pk_bf16_f32 v61, v61, v61
    v_cvt_pk_bf16_f32 v62, v62, v62
    v_cvt_pk_bf16_f32 v63, v63, v63
    v_and_b32 v68, v60, v2
    v_and_b32 v69, v60, v3
    v_and_b32 v70, v60, v4
    v_and_b32 v71, v60, v5
    v_and_b32 v72, v61, v2
    v_and_b32 v73, v61, v3
    v_and_b32 v74, v61, v4
    v_and_b32 v75, v61, v5
    v_mfma_f32_16x16x32_bf16 v[176:179], v[68:71], v[160:163], v[176:179]
    v_and_b32 v76, v62, v2
    v_and_b32 v77, v62, v3
    v_and_b32 v78, v62, v4
    v_and_b32 v79, v62, v5
    v_mfma_f32_16x16x32_bf16 v[176:179], v[72:75], v[164:167], v[176:179]
    v_and_b32 v80, v63, v2
    v_and_b32 v81, v63, v3
    v_and_b32 v82, v63, v4
    v_and_b32 v83, v63, v5
    v_mfma_f32_16x16x32_bf16 v[176:179], v[76:79], v[168:171], v[176:179]
    s_nop 1
    v_mfma_f32_16x16x32_bf16 v[176:179], v[80:83], v[172:175], v[176:179]
    s_mov_b32 exec_lo, 0xffffffff
    s_mov_b32 exec_hi, 0x0
    s_nop 5
    v_bfi_b32 v176, 15, s84, v176
    v_bfi_b32 v177, 15, s85, v177
    v_bfi_b32 v178, 15, s86, v178
    v_bfi_b32 v179, 15, s87, v179
    buffer_store_dwordx4 v[176:179], v183, s[48:51], s75 offen sc1
    s_mov_b64 exec, -1
    s_cmp_lt_u32 s68, 36
    s_cbranch_scc0 L_finish
    s_mul_i32 s58, s68, 32
    v_lshl_add_u32 v11, v0, 3, s58
    ds_read_b128 v[6:9], v1 offset:12288
    s_mov_b32 s40, s24
    s_and_b32 s41, s25, 0xffff
    s_mov_b32 s42, 0x480
    s_mov_b32 s43, 0x20000
L_gather:
    buffer_load_dwordx4 v[40:43], v238, s[48:51], s80 offen sc1
    buffer_load_dwordx4 v[44:47], v238, s[48:51], s81 offen sc1
    buffer_load_dwordx4 v[48:51], v238, s[48:51], s82 offen sc1
    buffer_load_dwordx4 v[52:55], v238, s[48:51], s83 offen sc1
    s_waitcnt vmcnt(0)
    v_xor_b32 v32, s84, v40
    v_xor_b32 v33, s85, v41
    v_xor_b32 v34, s86, v42
    v_xor_b32 v35, s87, v43
    v_or3_b32 v32, v32, v33, v34
    v_or_b32 v20, v32, v35
    v_xor_b32 v32, s84, v44
    v_xor_b32 v33, s85, v45
    v_xor_b32 v34, s86, v46
    v_xor_b32 v35, s87, v47
    v_or3_b32 v32, v32, v33, v34
    v_or3_b32 v20, v20, v32, v35
    v_xor_b32 v32, s84, v48
    v_xor_b32 v33, s85, v49
    v_xor_b32 v34, s86, v50
    v_xor_b32 v35, s87, v51
    v_or3_b32 v32, v32, v33, v34
    v_or3_b32 v20, v20, v32, v35
    v_xor_b32 v32, s84, v52
    v_xor_b32 v33, s85, v53
    v_xor_b32 v34, s86, v54
    v_xor_b32 v35, s87, v55
    v_or3_b32 v32, v32, v33, v34
    v_or3_b32 v20, v20, v32, v35
    v_and_b32 v20, 15, v20
    s_nop 1
    v_or_b32_dpp v20, v20, v20 quad_perm:[1,0,3,2] row_mask:0xf bank_mask:0xf
    s_nop 1
    v_or_b32_dpp v20, v20, v20 quad_perm:[2,3,0,1] row_mask:0xf bank_mask:0xf
    v_cmp_ne_u32 vcc, 0, v20
    s_and_b64 exec, exec, vcc
    s_cbranch_execz L_gathered
    s_add_u32 s78, s78, 1
    s_cmp_lt_u32 s78, 0x200000
    s_cbranch_scc1 L_gather
L_gathered:
    s_mov_b64 exec, -1
    v_and_b32 v40, -16, v40
    v_and_b32 v41, -16, v41
    v_and_b32 v42, -16, v42
    v_and_b32 v43, -16, v43
    v_and_b32 v44, -16, v44
    v_and_b32 v45, -16, v45
    v_and_b32 v46, -16, v46
    v_and_b32 v47, -16, v47
    v_and_b32 v48, -16, v48
    v_and_b32 v49, -16, v49
    v_and_b32 v50, -16, v50
    v_and_b32 v51, -16, v51
    v_and_b32 v52, -16, v52
    v_and_b32 v53, -16, v53
    v_and_b32 v54, -16, v54
    v_and_b32 v55, -16, v55
    v_add_f32 v40, v40, v44
    v_add_f32 v41, v41, v45
    v_add_f32 v42, v42, v46
    v_add_f32 v43, v43, v47
    v_add_f32 v48, v48, v52
    v_add_f32 v49, v49, v53
    v_add_f32 v50, v50, v54
    v_add_f32 v51, v51, v55
    v_add_f32 v40, v40, v48
    v_add_f32 v41, v41, v49
    v_add_f32 v42, v42, v50
    v_add_f32 v43, v43, v51
    v_add_f32_dpp v40, v40, v40 row_ror:4 row_mask:0xf bank_mask:0xf
    v_add_f32_dpp v41, v41, v41 row_ror:4 row_mask:0xf bank_mask:0xf
    v_add_f32_dpp v42, v42, v42 row_ror:4 row_mask:0xf bank_mask:0xf
    v_add_f32_dpp v43, v43, v43 row_ror:4 row_mask:0xf bank_mask:0xf
    v_add_f32_dpp v40, v40, v40 row_ror:8 row_mask:0xf bank_mask:0xf
    v_add_f32_dpp v41, v41, v41 row_ror:8 row_mask:0xf bank_mask:0xf
    v_add_f32_dpp v42, v42, v42 row_ror:8 row_mask:0xf bank_mask:0xf
    v_add_f32_dpp v43, v43, v43 row_ror:8 row_mask:0xf bank_mask:0xf
    v_mov_b32 v44, v40
    v_mov_b32 v45, v41
    v_mov_b32 v46, v42
    v_mov_b32 v47, v43
    v_permlane16_swap_b32 v40, v44
    v_permlane16_swap_b32 v41, v45
    v_permlane16_swap_b32 v42, v46
    v_permlane16_swap_b32 v43, v47
    v_add_f32 v40, v40, v44
    v_add_f32 v41, v41, v45
    v_add_f32 v42, v42, v46
    v_add_f32 v43, v43, v47
    v_mov_b32 v44, v40
    v_mov_b32 v45, v41
    v_mov_b32 v46, v42
    v_mov_b32 v47, v43
    v_permlane32_swap_b32 v40, v44
    v_permlane32_swap_b32 v41, v45
    v_permlane32_swap_b32 v42, v46
    v_permlane32_swap_b32 v43, v47
    v_add_f32 v40, v40, v44
    v_add_f32 v41, v41, v45
    v_add_f32 v42, v42, v46
    v_add_f32 v43, v43, v47
    s_mul_i32 s58, s52, 64
    v_lshl_add_u32 v20, v0, 4, s58
    s_mov_b64 exec, 15
    ds_write_b128 v20, v[40:43] offset:15360
    s_waitcnt lgkmcnt(0)
    s_barrier
    s_cmp_eq_u32 s52, 0
    s_cbranch_scc0 L_finish
    ds_read_b128 v[32:35], v20 offset:15360
    ds_read_b128 v[36:39], v20 offset:15424
    ds_read_b128 v[40:43], v20 offset:15488
    ds_read_b128 v[44:47], v20 offset:15552
    s_waitcnt lgkmcnt(3)
    v_add_f32 v6, v6, v32
    v_add_f32 v7, v7, v33
    v_add_f32 v8, v8, v34
    v_add_f32 v9, v9, v35
    s_waitcnt lgkmcnt(2)
    v_add_f32 v6, v6, v36
    v_add_f32 v7, v7, v37
    v_add_f32 v8, v8, v38
    v_add_f32 v9, v9, v39
    s_waitcnt lgkmcnt(1)
    v_add_f32 v6, v6, v40
    v_add_f32 v7, v7, v41
    v_add_f32 v8, v8, v42
    v_add_f32 v9, v9, v43
    s_waitcnt lgkmcnt(0)
    v_add_f32 v6, v6, v44
    v_add_f32 v7, v7, v45
    v_add_f32 v8, v8, v46
    v_add_f32 v9, v9, v47
    v_cvt_pk_bf16_f32 v32, v6, v7
    v_cvt_pk_bf16_f32 v33, v8, v9
    buffer_store_dwordx2 v[32:33], v11, s[40:43], 0 offen
    s_cmp_eq_u32 s68, 0
    s_cbranch_scc0 L_finish
    s_mov_b64 exec, 1
    v_mov_b32 v22, s66
    v_mov_b32 v23, s67
    buffer_store_dwordx2 v[22:23], v20, s[48:51], 0 offen offset:0
L_finish:
    s_endpgm
L_helper:
    v_lshlrev_b32 v1, 2, v0
    v_lshrrev_b32 v8, 4, v0
    v_and_b32 v9, 15, v0
    v_lshlrev_b32 v9, 4, v9
    v_mul_u32_u24 v7, 147456, v8
    v_add_u32 v7, v7, v9
    v_mul_u32_u24 v16, 165888, v8
    v_add_u32 v16, v16, v9
    s_mul_i32 s58, s54, 589824
    s_lshl_b32 s59, s53, 8
    s_add_u32 s58, s58, s59
    s_mul_i32 s79, s54, 663552
    s_mul_i32 s59, s53, 288
    s_add_u32 s79, s79, s59
    v_mov_b32 v20, -1
    v_mov_b32 v24, 0
    v_mov_b32 v21, -1
    v_mov_b32 v25, 0
    v_mov_b32 v22, -1
    v_mov_b32 v26, 0
    v_mov_b32 v23, -1
    v_mov_b32 v27, 0
    v_mov_b32 v28, 20
    v_mov_b32 v29, 20
    v_mov_b32 v30, 20
    v_mov_b32 v31, 20
    s_mov_b64 exec, 1
    ds_write_b128 v1, v[28:31] offset:13312
    ds_write_b128 v1, v[20:23] offset:10752
    ds_write_b128 v1, v[24:27] offset:10768
    ds_write_b64 v1, v[24:25] offset:10888
    s_mov_b64 exec, -1
    s_waitcnt lgkmcnt(0)
    s_mov_b32 s40, s4
    s_and_b32 s41, s5, 0xffff
    s_mov_b32 s42, 0x480
    s_mov_b32 s43, 0x20000
    buffer_load_dword v10, v1, s[40:43], 0 offen offset:0
    buffer_load_dword v11, v1, s[40:43], 0 offen offset:256
    buffer_load_dword v12, v1, s[40:43], 0 offen offset:512
    buffer_load_dword v13, v1, s[40:43], 0 offen offset:768
    buffer_load_dword v14, v1, s[40:43], 0 offen offset:1024
    s_mul_i32 s59, s54, 144
    buffer_load_dword v15, v1, s[40:43], s59 offen
    s_mov_b32 s44, s10
    s_and_b32 s45, s11, 0xffff
    s_mov_b32 s46, 0x480000
    s_mov_b32 s47, 0x20000
    buffer_load_dwordx4 v[96:99], v7, s[44:47], s58 offen nt
    s_add_u32 s58, s58, 8192
    buffer_load_dwordx4 v[100:103], v7, s[44:47], s58 offen nt
    s_add_u32 s58, s58, 8192
    buffer_load_dwordx4 v[104:107], v7, s[44:47], s58 offen nt
    s_add_u32 s58, s58, 8192
    buffer_load_dwordx4 v[108:111], v7, s[44:47], s58 offen nt
    s_add_u32 s58, s58, 8192
    buffer_load_dwordx4 v[112:115], v7, s[44:47], s58 offen nt
    s_add_u32 s58, s58, 8192
    buffer_load_dwordx4 v[116:119], v7, s[44:47], s58 offen nt
    s_add_u32 s58, s58, 8192
    buffer_load_dwordx4 v[120:123], v7, s[44:47], s58 offen nt
    s_add_u32 s58, s58, 8192
    buffer_load_dwordx4 v[124:127], v7, s[44:47], s58 offen nt
    s_add_u32 s58, s58, 8192
    buffer_load_dwordx4 v[128:131], v7, s[44:47], s58 offen nt
    s_add_u32 s58, s58, 8192
    buffer_load_dwordx4 v[132:135], v7, s[44:47], s58 offen nt
    s_add_u32 s58, s58, 8192
    buffer_load_dwordx4 v[136:139], v7, s[44:47], s58 offen nt
    s_add_u32 s58, s58, 8192
    buffer_load_dwordx4 v[140:143], v7, s[44:47], s58 offen nt
    s_add_u32 s58, s58, 8192
    buffer_load_dwordx4 v[144:147], v7, s[44:47], s58 offen nt
    s_add_u32 s58, s58, 8192
    buffer_load_dwordx4 v[148:151], v7, s[44:47], s58 offen nt
    s_add_u32 s58, s58, 8192
    buffer_load_dwordx4 v[152:155], v7, s[44:47], s58 offen nt
    s_add_u32 s58, s58, 8192
    buffer_load_dwordx4 v[156:159], v7, s[44:47], s58 offen nt
    s_add_u32 s58, s58, 8192
    buffer_load_dwordx4 v[160:163], v7, s[44:47], s58 offen nt
    s_add_u32 s58, s58, 8192
    buffer_load_dwordx4 v[164:167], v7, s[44:47], s58 offen nt
    s_barrier
    s_load_dwordx2 s[30:31], s[28:29], 0
    s_mov_b32 s48, s28
    s_and_b32 s49, s29, 0xffff
    s_mov_b32 s50, 0x1a0000
    s_mov_b32 s51, 0x20000
    v_and_b32 v20, 1, v0
    v_lshlrev_b32 v20, 4, v20
    v_mov_b32 v21, 0xffff
    v_lshlrev_b32 v20, v20, v21
    v_bfe_u32 v21, v0, 1, 2
    v_cmp_eq_u32 vcc, 0, v21
    s_nop 1
    v_cndmask_b32 v2, 0, v20, vcc
    v_cmp_eq_u32 vcc, 1, v21
    s_nop 1
    v_cndmask_b32 v3, 0, v20, vcc
    v_cmp_eq_u32 vcc, 2, v21
    s_nop 1
    v_cndmask_b32 v4, 0, v20, vcc
    v_cmp_eq_u32 vcc, 3, v21
    s_nop 1
    v_cndmask_b32 v5, 0, v20, vcc
    s_mov_b32 s65, 0x3fb8aa3b
    s_mov_b32 s60, -1
    s_mov_b32 s61, 0
    v_lshlrev_b32 v6, 4, v0
    v_lshlrev_b32 v54, 3, v0
    v_mul_u32_u24 v55, 72, v8
    v_and_b32 v19, 7, v0
    v_lshlrev_b32 v19, 4, v19
    v_and_b32 v18, 16, v0
    v_lshl_add_u32 v18, v9, 1, v18
    s_getreg_b32 s56, hwreg(HW_REG_XCC_ID, 0, 4)
    s_lshl_b32 s58, s55, 4
    s_add_u32 s58, s58, 0x2000
    s_lshl_b32 s81, s53, 7
    s_add_u32 s81, s81, 0x2000
    v_mov_b32 v92, s56
    v_mov_b32 v94, s56
    s_waitcnt lgkmcnt(0)
    s_add_u32 s66, s30, 0x9e3779b9
    s_add_u32 s67, s31, 0x7f4a7c15
    s_lshr_b32 s84, s66, 0
    s_lshr_b32 s85, s66, 4
    s_lshr_b32 s86, s66, 8
    s_lshr_b32 s87, s66, 12
    v_mov_b32 v93, s66
    v_mov_b32 v95, s67
    s_mov_b64 exec, 1
    buffer_store_dwordx4 v[92:95], v6, s[48:51], s58 offen sc1
    s_mov_b64 exec, -1
    s_lshl_b32 s58, s55, 9
    s_add_u32 s58, s58, 0x10000
    s_mul_i32 s59, s55, 576
    s_add_u32 s59, s59, 0x30000
    v_lshlrev_b32 v50, 6, v0
    s_mov_b64 exec, 0xff
    buffer_load_dword v51, v50, s[48:51], s58 offen sc1
    s_mov_b64 exec, 0x1ff
    buffer_load_dword v51, v50, s[48:51], s59 offen sc1
    s_lshl_b32 s58, s55, 11
    s_add_u32 s58, s58, 0x100000
    s_mov_b32 exec_lo, -1
    buffer_load_dword v51, v50, s[48:51], s58 offen sc1
    s_mov_b64 exec, -1
    s_waitcnt vmcnt(22)
    v_lshlrev_b32 v20, 16, v10
    v_and_b32 v21, 0xffff0000, v10
    v_lshlrev_b32 v22, 16, v11
    v_and_b32 v23, 0xffff0000, v11
    v_lshlrev_b32 v24, 16, v12
    v_and_b32 v25, 0xffff0000, v12
    v_lshlrev_b32 v26, 16, v13
    v_and_b32 v27, 0xffff0000, v13
    v_lshlrev_b32 v28, 16, v14
    v_and_b32 v29, 0xffff0000, v14
    v_add_f32 v30, v20, v21
    v_add_f32 v30, v30, v22
    v_add_f32 v30, v30, v23
    v_add_f32 v30, v30, v24
    v_add_f32 v30, v30, v25
    v_add_f32 v30, v30, v26
    v_add_f32 v30, v30, v27
    v_add_f32 v30, v30, v28
    v_add_f32 v30, v30, v29
    s_nop 1
    v_add_f32_dpp v30, v30, v30 row_ror:8 row_mask:0xf bank_mask:0xf
    s_nop 1
    v_add_f32_dpp v30, v30, v30 row_ror:4 row_mask:0xf bank_mask:0xf
    s_nop 1
    v_add_f32_dpp v30, v30, v30 row_ror:2 row_mask:0xf bank_mask:0xf
    s_nop 1
    v_add_f32_dpp v30, v30, v30 row_ror:1 row_mask:0xf bank_mask:0xf
    v_mov_b32 v31, v30
    s_nop 1
    v_permlane16_swap_b32 v30, v31
    v_add_f32 v30, v30, v31
    v_mov_b32 v31, v30
    s_nop 1
    v_permlane32_swap_b32 v30, v31
    v_add_f32 v30, v30, v31
    v_mul_f32 v32, 0x3ae38e39, v30
    v_sub_f32 v40, v20, v32
    v_sub_f32 v41, v21, v32
    v_sub_f32 v42, v22, v32
    v_sub_f32 v43, v23, v32
    v_sub_f32 v44, v24, v32
    v_sub_f32 v45, v25, v32
    v_sub_f32 v46, v26, v32
    v_sub_f32 v47, v27, v32
    v_sub_f32 v48, v28, v32
    v_sub_f32 v49, v29, v32
    v_cndmask_b32 v48, 0, v48, s[60:61]
    v_cndmask_b32 v49, 0, v49, s[60:61]
    v_mul_f32 v30, v40, v40
    v_fmac_f32 v30, v41, v41
    v_fmac_f32 v30, v42, v42
    v_fmac_f32 v30, v43, v43
    v_fmac_f32 v30, v44, v44
    v_fmac_f32 v30, v45, v45
    v_fmac_f32 v30, v46, v46
    v_fmac_f32 v30, v47, v47
    v_fmac_f32 v30, v48, v48
    v_fmac_f32 v30, v49, v49
    s_nop 1
    v_add_f32_dpp v30, v30, v30 row_ror:8 row_mask:0xf bank_mask:0xf
    s_nop 1
    v_add_f32_dpp v30, v30, v30 row_ror:4 row_mask:0xf bank_mask:0xf
    s_nop 1
    v_add_f32_dpp v30, v30, v30 row_ror:2 row_mask:0xf bank_mask:0xf
    s_nop 1
    v_add_f32_dpp v30, v30, v30 row_ror:1 row_mask:0xf bank_mask:0xf
    v_mov_b32 v31, v30
    s_nop 1
    v_permlane16_swap_b32 v30, v31
    v_add_f32 v30, v30, v31
    v_mov_b32 v31, v30
    s_nop 1
    v_permlane32_swap_b32 v30, v31
    v_add_f32 v30, v30, v31
    v_mul_f32 v33, 0x3ae38e39, v30
    v_cvt_pk_bf16_f32 v32, v32, v32
    v_and_b32 v32, 0xffff0000, v32
    v_cvt_pk_bf16_f32 v33, v33, v33
    v_and_b32 v33, 0xffff0000, v33
    v_add_f32 v33, 0x3727c5ac, v33
    v_cvt_pk_bf16_f32 v33, v33, v33
    v_and_b32 v33, 0xffff0000, v33
    v_sqrt_f32 v33, v33
    v_lshlrev_b32 v40, 16, v15
    v_and_b32 v41, 0xffff0000, v15
    v_sub_f32 v40, v40, v32
    v_sub_f32 v41, v41, v32
    v_cvt_pk_bf16_f32 v33, v33, v33
    v_and_b32 v33, 0xffff0000, v33
    v_rcp_f32 v34, v33
    v_cvt_pk_bf16_f32 v40, v40, v40
    v_and_b32 v40, 0xffff0000, v40
    v_cvt_pk_bf16_f32 v41, v41, v41
    v_and_b32 v41, 0xffff0000, v41
    v_mul_f32 v20, v40, v34
    v_mul_f32 v21, v41, v34
    v_fma_f32 v40, -v20, v33, v40
    v_fma_f32 v41, -v21, v33, v41
    v_fmac_f32 v20, v40, v34
    v_fmac_f32 v21, v41, v34
    v_cvt_pk_bf16_f32 v20, v20, v20
    v_cvt_pk_bf16_f32 v21, v21, v21
    ds_write_b64 v54, v[20:21] offset:8192
    ds_read_b64 v[60:61], v55 offset:8192
    ds_read_b64 v[62:63], v55 offset:8200
    ds_read_b64 v[64:65], v55 offset:8208
    ds_read_b64 v[66:67], v55 offset:8216
    ds_read_b64 v[68:69], v55 offset:8224
    ds_read_b64 v[70:71], v55 offset:8232
    ds_read_b64 v[72:73], v55 offset:8240
    ds_read_b64 v[74:75], v55 offset:8248
    ds_read_b64 v[76:77], v55 offset:8256
    s_waitcnt lgkmcnt(0)
    v_and_b32 v84, v60, v2
    v_and_b32 v85, v60, v3
    v_and_b32 v86, v60, v4
    v_and_b32 v87, v60, v5
    v_and_b32 v88, v61, v2
    v_and_b32 v89, v61, v3
    v_and_b32 v90, v61, v4
    v_and_b32 v91, v61, v5
    s_waitcnt vmcnt(19)
    v_mfma_f32_16x16x32_bf16 v[80:83], v[84:87], v[96:99], 0
    v_and_b32 v84, v62, v2
    v_and_b32 v85, v62, v3
    v_and_b32 v86, v62, v4
    v_and_b32 v87, v62, v5
    v_mfma_f32_16x16x32_bf16 v[80:83], v[88:91], v[100:103], v[80:83]
    v_and_b32 v88, v63, v2
    v_and_b32 v89, v63, v3
    v_and_b32 v90, v63, v4
    v_and_b32 v91, v63, v5
    v_mfma_f32_16x16x32_bf16 v[80:83], v[84:87], v[104:107], v[80:83]
    v_and_b32 v84, v64, v2
    v_and_b32 v85, v64, v3
    v_and_b32 v86, v64, v4
    v_and_b32 v87, v64, v5
    s_waitcnt vmcnt(16)
    v_mfma_f32_16x16x32_bf16 v[80:83], v[88:91], v[108:111], v[80:83]
    v_and_b32 v88, v65, v2
    v_and_b32 v89, v65, v3
    v_and_b32 v90, v65, v4
    v_and_b32 v91, v65, v5
    v_mfma_f32_16x16x32_bf16 v[80:83], v[84:87], v[112:115], v[80:83]
    v_and_b32 v84, v66, v2
    v_and_b32 v85, v66, v3
    v_and_b32 v86, v66, v4
    v_and_b32 v87, v66, v5
    v_mfma_f32_16x16x32_bf16 v[80:83], v[88:91], v[116:119], v[80:83]
    v_and_b32 v88, v67, v2
    v_and_b32 v89, v67, v3
    v_and_b32 v90, v67, v4
    v_and_b32 v91, v67, v5
    s_waitcnt vmcnt(13)
    v_mfma_f32_16x16x32_bf16 v[80:83], v[84:87], v[120:123], v[80:83]
    v_and_b32 v84, v68, v2
    v_and_b32 v85, v68, v3
    v_and_b32 v86, v68, v4
    v_and_b32 v87, v68, v5
    v_mfma_f32_16x16x32_bf16 v[80:83], v[88:91], v[124:127], v[80:83]
    v_and_b32 v88, v69, v2
    v_and_b32 v89, v69, v3
    v_and_b32 v90, v69, v4
    v_and_b32 v91, v69, v5
    v_mfma_f32_16x16x32_bf16 v[80:83], v[84:87], v[128:131], v[80:83]
    v_and_b32 v84, v70, v2
    v_and_b32 v85, v70, v3
    v_and_b32 v86, v70, v4
    v_and_b32 v87, v70, v5
    s_waitcnt vmcnt(10)
    v_mfma_f32_16x16x32_bf16 v[80:83], v[88:91], v[132:135], v[80:83]
    v_and_b32 v88, v71, v2
    v_and_b32 v89, v71, v3
    v_and_b32 v90, v71, v4
    v_and_b32 v91, v71, v5
    v_mfma_f32_16x16x32_bf16 v[80:83], v[84:87], v[136:139], v[80:83]
    v_and_b32 v84, v72, v2
    v_and_b32 v85, v72, v3
    v_and_b32 v86, v72, v4
    v_and_b32 v87, v72, v5
    v_mfma_f32_16x16x32_bf16 v[80:83], v[88:91], v[140:143], v[80:83]
    v_and_b32 v88, v73, v2
    v_and_b32 v89, v73, v3
    v_and_b32 v90, v73, v4
    v_and_b32 v91, v73, v5
    s_waitcnt vmcnt(7)
    v_mfma_f32_16x16x32_bf16 v[80:83], v[84:87], v[144:147], v[80:83]
    v_and_b32 v84, v74, v2
    v_and_b32 v85, v74, v3
    v_and_b32 v86, v74, v4
    v_and_b32 v87, v74, v5
    v_mfma_f32_16x16x32_bf16 v[80:83], v[88:91], v[148:151], v[80:83]
    v_and_b32 v88, v75, v2
    v_and_b32 v89, v75, v3
    v_and_b32 v90, v75, v4
    v_and_b32 v91, v75, v5
    v_mfma_f32_16x16x32_bf16 v[80:83], v[84:87], v[152:155], v[80:83]
    v_and_b32 v84, v76, v2
    v_and_b32 v85, v76, v3
    v_and_b32 v86, v76, v4
    v_and_b32 v87, v76, v5
    s_waitcnt vmcnt(4)
    v_mfma_f32_16x16x32_bf16 v[80:83], v[88:91], v[156:159], v[80:83]
    v_and_b32 v88, v77, v2
    v_and_b32 v89, v77, v3
    v_and_b32 v90, v77, v4
    v_and_b32 v91, v77, v5
    v_mfma_f32_16x16x32_bf16 v[80:83], v[84:87], v[160:163], v[80:83]
    s_nop 0
    v_mfma_f32_16x16x32_bf16 v[80:83], v[88:91], v[164:167], v[80:83]
    s_lshl_b32 s58, s55, 9
    s_add_u32 s58, s58, 0x10000
    s_lshl_b32 s80, s53, 12
    s_add_u32 s80, s80, 0x10000
    s_mov_b32 exec_hi, 0
    s_nop 2
    v_bfi_b32 v80, 15, s84, v80
    v_bfi_b32 v81, 15, s85, v81
    v_bfi_b32 v82, 15, s86, v82
    v_bfi_b32 v83, 15, s87, v83
    buffer_store_dwordx4 v[80:83], v18, s[48:51], s58 offen
    s_mov_b64 exec, -1
    buffer_load_dwordx4 v[56:59], v19, s[48:51], s81 offen sc1
    s_mov_b32 s82, s58
    s_mov_b32 s57, 2
    v_lshrrev_b32 v52, 5, v0
    v_mul_u32_u24 v52, 512, v52
    v_and_b32 v53, 31, v0
    v_lshl_add_u32 v52, v53, 4, v52
L_q_poll:
    buffer_load_dwordx4 v[20:23], v52, s[48:51], s80 offen offset:0 sc1
    buffer_load_dwordx4 v[24:27], v52, s[48:51], s80 offen offset:1024 sc1
    buffer_load_dwordx4 v[28:31], v52, s[48:51], s80 offen offset:2048 sc1
    buffer_load_dwordx4 v[32:35], v52, s[48:51], s80 offen offset:3072 sc1
    s_waitcnt vmcnt(0)
    v_xor_b32 v40, s84, v20
    v_xor_b32 v41, s85, v21
    v_xor_b32 v42, s86, v22
    v_xor_b32 v43, s87, v23
    v_or3_b32 v40, v40, v41, v42
    v_or_b32 v53, v40, v43
    v_xor_b32 v40, s84, v24
    v_xor_b32 v41, s85, v25
    v_xor_b32 v42, s86, v26
    v_xor_b32 v43, s87, v27
    v_or3_b32 v40, v40, v41, v42
    v_or3_b32 v53, v53, v40, v43
    v_xor_b32 v40, s84, v28
    v_xor_b32 v41, s85, v29
    v_xor_b32 v42, s86, v30
    v_xor_b32 v43, s87, v31
    v_or3_b32 v40, v40, v41, v42
    v_or3_b32 v53, v53, v40, v43
    v_xor_b32 v40, s84, v32
    v_xor_b32 v41, s85, v33
    v_xor_b32 v42, s86, v34
    v_xor_b32 v43, s87, v35
    v_or3_b32 v40, v40, v41, v42
    v_or3_b32 v53, v53, v40, v43
    v_and_b32 v53, 15, v53
    v_cmp_ne_u32 vcc, 0, v53
    s_and_b64 vcc, vcc, exec
    s_cbranch_scc0 L_q_done
    s_cmp_eq_u32 s57, 2
    s_cbranch_scc0 L_known67
    v_xor_b32 v57, s66, v57
    v_xor_b32 v59, s67, v59
    v_or_b32 v57, v57, v59
    v_cmp_ne_u32 vcc, 0, v57
    s_and_b64 vcc, vcc, exec
    s_cbranch_scc0 L_all67
    buffer_load_dwordx4 v[56:59], v19, s[48:51], s81 offen sc1
    s_branch L_known67
L_all67:
    v_cmp_ne_u32 vcc, s56, v56
    s_and_b64 vcc, vcc, exec
    s_cselect_b32 s57, 0, 1
    s_cbranch_scc0 L_known67
    s_mov_b32 exec_hi, 0
    buffer_store_dwordx4 v[80:83], v18, s[48:51], s82 offen sc1
    s_mov_b64 exec, -1
L_known67:
    s_add_u32 s78, s78, 1
    s_cmp_lt_u32 s78, 0x200000
    s_cbranch_scc1 L_q_poll
L_q_done:
    v_and_b32 v20, -16, v20
    v_and_b32 v21, -16, v21
    v_and_b32 v22, -16, v22
    v_and_b32 v23, -16, v23
    v_and_b32 v24, -16, v24
    v_and_b32 v25, -16, v25
    v_and_b32 v26, -16, v26
    v_and_b32 v27, -16, v27
    v_and_b32 v28, -16, v28
    v_and_b32 v29, -16, v29
    v_and_b32 v30, -16, v30
    v_and_b32 v31, -16, v31
    v_and_b32 v32, -16, v32
    v_and_b32 v33, -16, v33
    v_and_b32 v34, -16, v34
    v_and_b32 v35, -16, v35
    v_add_f32 v20, v20, v24
    v_add_f32 v21, v21, v25
    v_add_f32 v22, v22, v26
    v_add_f32 v23, v23, v27
    v_add_f32 v28, v28, v32
    v_add_f32 v29, v29, v33
    v_add_f32 v30, v30, v34
    v_add_f32 v31, v31, v35
    v_add_f32 v20, v20, v28
    v_add_f32 v21, v21, v29
    v_add_f32 v22, v22, v30
    v_add_f32 v23, v23, v31
    v_mov_b32 v24, v20
    v_mov_b32 v25, v21
    v_mov_b32 v26, v22
    v_mov_b32 v27, v23
    v_permlane32_swap_b32 v20, v24
    v_permlane32_swap_b32 v21, v25
    v_permlane32_swap_b32 v22, v26
    v_permlane32_swap_b32 v23, v27
    v_add_f32 v20, v20, v24
    v_add_f32 v21, v21, v25
    v_add_f32 v22, v22, v26
    v_add_f32 v23, v23, v27
    v_cvt_pk_bf16_f32 v24, v20, v21
    v_cvt_pk_bf16_f32 v25, v22, v23
    s_mov_b32 exec_hi, 0
    ds_write_b64 v54, v[24:25] offset:10496
    s_mov_b64 exec, -1
    v_mov_b32 v20, 10768
    v_mov_b32 v21, 1
    ds_write_b32 v20, v21
L_ids:
    s_cmp_eq_u32 s57, 2
    s_cbranch_scc0 L_known68
    v_xor_b32 v57, s66, v57
    v_xor_b32 v59, s67, v59
    v_or_b32 v57, v57, v59
    v_cmp_ne_u32 vcc, 0, v57
    s_and_b64 vcc, vcc, exec
    s_cbranch_scc0 L_all68
    buffer_load_dwordx4 v[56:59], v19, s[48:51], s81 offen sc1
    s_branch L_known68
L_all68:
    v_cmp_ne_u32 vcc, s56, v56
    s_and_b64 vcc, vcc, exec
    s_cselect_b32 s57, 0, 1
    s_cbranch_scc0 L_known68
    s_mov_b32 exec_hi, 0
    buffer_store_dwordx4 v[80:83], v18, s[48:51], s82 offen sc1
    s_mov_b64 exec, -1
L_known68:
    s_cmp_eq_u32 s57, 2
    s_cbranch_scc0 L_ids_ok
    s_waitcnt vmcnt(0)
    s_sleep 2
    s_add_u32 s78, s78, 1
    s_cmp_lt_u32 s78, 0x200000
    s_cbranch_scc1 L_ids
L_ids_ok:
    s_mov_b32 s44, s16
    s_and_b32 s45, s17, 0xffff
    s_mov_b32 s46, 0x510000
    s_mov_b32 s47, 0x20000
    buffer_load_dwordx4 v[96:99], v16, s[44:47], s79 offen nt
    s_mov_b32 exec_lo, 0x30003
    s_mov_b32 exec_hi, 0x30003
    buffer_load_dwordx4 v[168:171], v16, s[44:47], s79 offen offset:256 nt
    s_mov_b64 exec, -1
    s_add_u32 s79, s79, 9216
    buffer_load_dwordx4 v[100:103], v16, s[44:47], s79 offen nt
    s_mov_b32 exec_lo, 0x30003
    s_mov_b32 exec_hi, 0x30003
    buffer_load_dwordx4 v[172:175], v16, s[44:47], s79 offen offset:256 nt
    s_mov_b64 exec, -1
    s_add_u32 s79, s79, 9216
    buffer_load_dwordx4 v[104:107], v16, s[44:47], s79 offen nt
    s_mov_b32 exec_lo, 0x30003
    s_mov_b32 exec_hi, 0x30003
    buffer_load_dwordx4 v[176:179], v16, s[44:47], s79 offen offset:256 nt
    s_mov_b64 exec, -1
    s_add_u32 s79, s79, 9216
    buffer_load_dwordx4 v[108:111], v16, s[44:47], s79 offen nt
    s_mov_b32 exec_lo, 0x30003
    s_mov_b32 exec_hi, 0x30003
    buffer_load_dwordx4 v[180:183], v16, s[44:47], s79 offen offset:256 nt
    s_mov_b64 exec, -1
    s_add_u32 s79, s79, 9216
    buffer_load_dwordx4 v[112:115], v16, s[44:47], s79 offen nt
    s_mov_b32 exec_lo, 0x30003
    s_mov_b32 exec_hi, 0x30003
    buffer_load_dwordx4 v[184:187], v16, s[44:47], s79 offen offset:256 nt
    s_mov_b64 exec, -1
    s_add_u32 s79, s79, 9216
    buffer_load_dwordx4 v[116:119], v16, s[44:47], s79 offen nt
    s_mov_b32 exec_lo, 0x30003
    s_mov_b32 exec_hi, 0x30003
    buffer_load_dwordx4 v[188:191], v16, s[44:47], s79 offen offset:256 nt
    s_mov_b64 exec, -1
    s_add_u32 s79, s79, 9216
    buffer_load_dwordx4 v[120:123], v16, s[44:47], s79 offen nt
    s_mov_b32 exec_lo, 0x30003
    s_mov_b32 exec_hi, 0x30003
    buffer_load_dwordx4 v[192:195], v16, s[44:47], s79 offen offset:256 nt
    s_mov_b64 exec, -1
    s_add_u32 s79, s79, 9216
    buffer_load_dwordx4 v[124:127], v16, s[44:47], s79 offen nt
    s_mov_b32 exec_lo, 0x30003
    s_mov_b32 exec_hi, 0x30003
    buffer_load_dwordx4 v[196:199], v16, s[44:47], s79 offen offset:256 nt
    s_mov_b64 exec, -1
    s_add_u32 s79, s79, 9216
    buffer_load_dwordx4 v[128:131], v16, s[44:47], s79 offen nt
    s_mov_b32 exec_lo, 0x30003
    s_mov_b32 exec_hi, 0x30003
    buffer_load_dwordx4 v[200:203], v16, s[44:47], s79 offen offset:256 nt
    s_mov_b64 exec, -1
    s_add_u32 s79, s79, 9216
    buffer_load_dwordx4 v[132:135], v16, s[44:47], s79 offen nt
    s_mov_b32 exec_lo, 0x30003
    s_mov_b32 exec_hi, 0x30003
    buffer_load_dwordx4 v[204:207], v16, s[44:47], s79 offen offset:256 nt
    s_mov_b64 exec, -1
    s_add_u32 s79, s79, 9216
    buffer_load_dwordx4 v[136:139], v16, s[44:47], s79 offen nt
    s_mov_b32 exec_lo, 0x30003
    s_mov_b32 exec_hi, 0x30003
    buffer_load_dwordx4 v[208:211], v16, s[44:47], s79 offen offset:256 nt
    s_mov_b64 exec, -1
    s_add_u32 s79, s79, 9216
    buffer_load_dwordx4 v[140:143], v16, s[44:47], s79 offen nt
    s_mov_b32 exec_lo, 0x30003
    s_mov_b32 exec_hi, 0x30003
    buffer_load_dwordx4 v[212:215], v16, s[44:47], s79 offen offset:256 nt
    s_mov_b64 exec, -1
    s_add_u32 s79, s79, 9216
    buffer_load_dwordx4 v[144:147], v16, s[44:47], s79 offen nt
    s_mov_b32 exec_lo, 0x30003
    s_mov_b32 exec_hi, 0x30003
    buffer_load_dwordx4 v[216:219], v16, s[44:47], s79 offen offset:256 nt
    s_mov_b64 exec, -1
    s_add_u32 s79, s79, 9216
    buffer_load_dwordx4 v[148:151], v16, s[44:47], s79 offen nt
    s_mov_b32 exec_lo, 0x30003
    s_mov_b32 exec_hi, 0x30003
    buffer_load_dwordx4 v[220:223], v16, s[44:47], s79 offen offset:256 nt
    s_mov_b64 exec, -1
    s_add_u32 s79, s79, 9216
    buffer_load_dwordx4 v[152:155], v16, s[44:47], s79 offen nt
    s_mov_b32 exec_lo, 0x30003
    s_mov_b32 exec_hi, 0x30003
    buffer_load_dwordx4 v[224:227], v16, s[44:47], s79 offen offset:256 nt
    s_mov_b64 exec, -1
    s_add_u32 s79, s79, 9216
    buffer_load_dwordx4 v[156:159], v16, s[44:47], s79 offen nt
    s_mov_b32 exec_lo, 0x30003
    s_mov_b32 exec_hi, 0x30003
    buffer_load_dwordx4 v[228:231], v16, s[44:47], s79 offen offset:256 nt
    s_mov_b64 exec, -1
    s_add_u32 s79, s79, 9216
    buffer_load_dwordx4 v[160:163], v16, s[44:47], s79 offen nt
    s_mov_b32 exec_lo, 0x30003
    s_mov_b32 exec_hi, 0x30003
    buffer_load_dwordx4 v[232:235], v16, s[44:47], s79 offen offset:256 nt
    s_mov_b64 exec, -1
    s_add_u32 s79, s79, 9216
    buffer_load_dwordx4 v[164:167], v16, s[44:47], s79 offen nt
    s_mov_b32 exec_lo, 0x30003
    s_mov_b32 exec_hi, 0x30003
    buffer_load_dwordx4 v[236:239], v16, s[44:47], s79 offen offset:256 nt
    s_mov_b64 exec, -1
    v_and_b32 v84, v60, v2
    v_and_b32 v85, v60, v3
    v_and_b32 v86, v60, v4
    v_and_b32 v87, v60, v5
    s_waitcnt vmcnt(34)
    s_nop 0
    v_mfma_f32_16x16x32_bf16 v[80:83], v[84:87], v[96:99], 0
    v_mfma_f32_16x16x32_bf16 v[88:91], v[84:87], v[168:171], 0
    v_and_b32 v84, v61, v2
    v_and_b32 v85, v61, v3
    v_and_b32 v86, v61, v4
    v_and_b32 v87, v61, v5
    s_waitcnt vmcnt(32)
    s_nop 0
    v_mfma_f32_16x16x32_bf16 v[80:83], v[84:87], v[100:103], v[80:83]
    v_mfma_f32_16x16x32_bf16 v[88:91], v[84:87], v[172:175], v[88:91]
    v_and_b32 v84, v62, v2
    v_and_b32 v85, v62, v3
    v_and_b32 v86, v62, v4
    v_and_b32 v87, v62, v5
    s_waitcnt vmcnt(30)
    s_nop 0
    v_mfma_f32_16x16x32_bf16 v[80:83], v[84:87], v[104:107], v[80:83]
    v_mfma_f32_16x16x32_bf16 v[88:91], v[84:87], v[176:179], v[88:91]
    v_and_b32 v84, v63, v2
    v_and_b32 v85, v63, v3
    v_and_b32 v86, v63, v4
    v_and_b32 v87, v63, v5
    s_waitcnt vmcnt(28)
    s_nop 0
    v_mfma_f32_16x16x32_bf16 v[80:83], v[84:87], v[108:111], v[80:83]
    v_mfma_f32_16x16x32_bf16 v[88:91], v[84:87], v[180:183], v[88:91]
    v_and_b32 v84, v64, v2
    v_and_b32 v85, v64, v3
    v_and_b32 v86, v64, v4
    v_and_b32 v87, v64, v5
    s_waitcnt vmcnt(26)
    s_nop 0
    v_mfma_f32_16x16x32_bf16 v[80:83], v[84:87], v[112:115], v[80:83]
    v_mfma_f32_16x16x32_bf16 v[88:91], v[84:87], v[184:187], v[88:91]
    v_and_b32 v84, v65, v2
    v_and_b32 v85, v65, v3
    v_and_b32 v86, v65, v4
    v_and_b32 v87, v65, v5
    s_waitcnt vmcnt(24)
    s_nop 0
    v_mfma_f32_16x16x32_bf16 v[80:83], v[84:87], v[116:119], v[80:83]
    v_mfma_f32_16x16x32_bf16 v[88:91], v[84:87], v[188:191], v[88:91]
    v_and_b32 v84, v66, v2
    v_and_b32 v85, v66, v3
    v_and_b32 v86, v66, v4
    v_and_b32 v87, v66, v5
    s_waitcnt vmcnt(22)
    s_nop 0
    v_mfma_f32_16x16x32_bf16 v[80:83], v[84:87], v[120:123], v[80:83]
    v_mfma_f32_16x16x32_bf16 v[88:91], v[84:87], v[192:195], v[88:91]
    v_and_b32 v84, v67, v2
    v_and_b32 v85, v67, v3
    v_and_b32 v86, v67, v4
    v_and_b32 v87, v67, v5
    s_waitcnt vmcnt(20)
    s_nop 0
    v_mfma_f32_16x16x32_bf16 v[80:83], v[84:87], v[124:127], v[80:83]
    v_mfma_f32_16x16x32_bf16 v[88:91], v[84:87], v[196:199], v[88:91]
    v_and_b32 v84, v68, v2
    v_and_b32 v85, v68, v3
    v_and_b32 v86, v68, v4
    v_and_b32 v87, v68, v5
    s_waitcnt vmcnt(18)
    s_nop 0
    v_mfma_f32_16x16x32_bf16 v[80:83], v[84:87], v[128:131], v[80:83]
    v_mfma_f32_16x16x32_bf16 v[88:91], v[84:87], v[200:203], v[88:91]
    v_and_b32 v84, v69, v2
    v_and_b32 v85, v69, v3
    v_and_b32 v86, v69, v4
    v_and_b32 v87, v69, v5
    s_waitcnt vmcnt(16)
    s_nop 0
    v_mfma_f32_16x16x32_bf16 v[80:83], v[84:87], v[132:135], v[80:83]
    v_mfma_f32_16x16x32_bf16 v[88:91], v[84:87], v[204:207], v[88:91]
    v_and_b32 v84, v70, v2
    v_and_b32 v85, v70, v3
    v_and_b32 v86, v70, v4
    v_and_b32 v87, v70, v5
    s_waitcnt vmcnt(14)
    s_nop 0
    v_mfma_f32_16x16x32_bf16 v[80:83], v[84:87], v[136:139], v[80:83]
    v_mfma_f32_16x16x32_bf16 v[88:91], v[84:87], v[208:211], v[88:91]
    v_and_b32 v84, v71, v2
    v_and_b32 v85, v71, v3
    v_and_b32 v86, v71, v4
    v_and_b32 v87, v71, v5
    s_waitcnt vmcnt(12)
    s_nop 0
    v_mfma_f32_16x16x32_bf16 v[80:83], v[84:87], v[140:143], v[80:83]
    v_mfma_f32_16x16x32_bf16 v[88:91], v[84:87], v[212:215], v[88:91]
    v_and_b32 v84, v72, v2
    v_and_b32 v85, v72, v3
    v_and_b32 v86, v72, v4
    v_and_b32 v87, v72, v5
    s_waitcnt vmcnt(10)
    s_nop 0
    v_mfma_f32_16x16x32_bf16 v[80:83], v[84:87], v[144:147], v[80:83]
    v_mfma_f32_16x16x32_bf16 v[88:91], v[84:87], v[216:219], v[88:91]
    v_and_b32 v84, v73, v2
    v_and_b32 v85, v73, v3
    v_and_b32 v86, v73, v4
    v_and_b32 v87, v73, v5
    s_waitcnt vmcnt(8)
    s_nop 0
    v_mfma_f32_16x16x32_bf16 v[80:83], v[84:87], v[148:151], v[80:83]
    v_mfma_f32_16x16x32_bf16 v[88:91], v[84:87], v[220:223], v[88:91]
    v_and_b32 v84, v74, v2
    v_and_b32 v85, v74, v3
    v_and_b32 v86, v74, v4
    v_and_b32 v87, v74, v5
    s_waitcnt vmcnt(6)
    s_nop 0
    v_mfma_f32_16x16x32_bf16 v[80:83], v[84:87], v[152:155], v[80:83]
    v_mfma_f32_16x16x32_bf16 v[88:91], v[84:87], v[224:227], v[88:91]
    v_and_b32 v84, v75, v2
    v_and_b32 v85, v75, v3
    v_and_b32 v86, v75, v4
    v_and_b32 v87, v75, v5
    s_waitcnt vmcnt(4)
    s_nop 0
    v_mfma_f32_16x16x32_bf16 v[80:83], v[84:87], v[156:159], v[80:83]
    v_mfma_f32_16x16x32_bf16 v[88:91], v[84:87], v[228:231], v[88:91]
    v_and_b32 v84, v76, v2
    v_and_b32 v85, v76, v3
    v_and_b32 v86, v76, v4
    v_and_b32 v87, v76, v5
    s_waitcnt vmcnt(2)
    s_nop 0
    v_mfma_f32_16x16x32_bf16 v[80:83], v[84:87], v[160:163], v[80:83]
    v_mfma_f32_16x16x32_bf16 v[88:91], v[84:87], v[232:235], v[88:91]
    v_and_b32 v84, v77, v2
    v_and_b32 v85, v77, v3
    v_and_b32 v86, v77, v4
    v_and_b32 v87, v77, v5
    s_waitcnt vmcnt(0)
    s_nop 0
    v_mfma_f32_16x16x32_bf16 v[80:83], v[84:87], v[164:167], v[80:83]
    v_mfma_f32_16x16x32_bf16 v[88:91], v[84:87], v[236:239], v[88:91]
    s_mul_i32 s58, s55, 576
    s_add_u32 s58, s58, 0x30000
    s_mul_i32 s80, s53, 4608
    s_add_u32 s80, s80, 0x30000
    s_mov_b32 exec_hi, 0
    s_nop 2
    v_bfi_b32 v80, 15, s84, v80
    v_bfi_b32 v81, 15, s85, v81
    v_bfi_b32 v82, 15, s86, v82
    v_bfi_b32 v83, 15, s87, v83
    v_bfi_b32 v88, 15, s84, v88
    v_bfi_b32 v89, 15, s85, v89
    v_bfi_b32 v90, 15, s86, v90
    v_bfi_b32 v91, 15, s87, v91
    s_cmp_eq_u32 s57, 1
    s_cbranch_scc1 L_near69
    buffer_store_dwordx4 v[80:83], v18, s[48:51], s58 offen sc1
    s_mov_b32 exec_lo, 0x00030003
    buffer_store_dwordx4 v[88:91], v18, s[48:51], s58 offen offset:512 sc1
    s_branch L_sent69
L_near69:
    buffer_store_dwordx4 v[80:83], v18, s[48:51], s58 offen
    s_mov_b32 exec_lo, 0x00030003
    buffer_store_dwordx4 v[88:91], v18, s[48:51], s58 offen offset:512
L_sent69:
    s_mov_b64 exec, -1
    s_mov_b32 s40, s18
    s_and_b32 s41, s19, 0xffff
    s_mov_b32 s42, 0x2400
    s_mov_b32 s43, 0x20000
    s_mul_i32 s79, s55, 36
    v_lshlrev_b32 v19, 1, v0
    v_mov_b32 v56, 0
    s_mov_b64 exec, 0x3ffff
    buffer_load_short_d16_hi v56, v19, s[40:43], s79 offen
    s_mov_b64 exec, -1
    v_mul_u32_u24 v52, 576, v0
    s_mov_b64 exec, 0xff
L_h_pre:
    buffer_load_dwordx4 v[20:23], v52, s[48:51], s80 offen sc1
    s_waitcnt vmcnt(0)
    v_xor_b32 v24, s84, v20
    v_xor_b32 v25, s85, v21
    v_xor_b32 v26, s86, v22
    v_xor_b32 v27, s87, v23
    v_or3_b32 v24, v24, v25, v26
    v_or_b32 v53, v24, v27
    v_and_b32 v53, 15, v53
    v_cmp_ne_u32 vcc, 0, v53
    s_and_b64 exec, exec, vcc
    s_cbranch_execz L_h_seen
    s_sleep 8
    s_add_u32 s78, s78, 1
    s_cmp_lt_u32 s78, 0x200000
    s_cbranch_scc1 L_h_pre
L_h_seen:
    s_mov_b64 exec, -1
    v_lshrrev_b32 v52, 5, v0
    v_mul_u32_u24 v52, 576, v52
    v_and_b32 v53, 31, v0
    v_lshl_add_u32 v52, v53, 4, v52
    v_lshrrev_b32 v54, 2, v53
    v_mul_u32_u24 v54, 576, v54
    v_and_b32 v53, 3, v0
    v_lshl_add_u32 v54, v53, 4, v54
L_h_poll:
    buffer_load_dwordx4 v[20:23], v52, s[48:51], s80 offen offset:0 sc1
    buffer_load_dwordx4 v[24:27], v52, s[48:51], s80 offen offset:1152 sc1
    buffer_load_dwordx4 v[28:31], v52, s[48:51], s80 offen offset:2304 sc1
    buffer_load_dwordx4 v[32:35], v52, s[48:51], s80 offen offset:3456 sc1
    buffer_load_dwordx4 v[36:39], v54, s[48:51], s80 offen offset:512 sc1
    s_waitcnt vmcnt(0)
    v_xor_b32 v40, s84, v20
    v_xor_b32 v41, s85, v21
    v_xor_b32 v42, s86, v22
    v_xor_b32 v43, s87, v23
    v_or3_b32 v40, v40, v41, v42
    v_or_b32 v53, v40, v43
    v_xor_b32 v40, s84, v24
    v_xor_b32 v41, s85, v25
    v_xor_b32 v42, s86, v26
    v_xor_b32 v43, s87, v27
    v_or3_b32 v40, v40, v41, v42
    v_or3_b32 v53, v53, v40, v43
    v_xor_b32 v40, s84, v28
    v_xor_b32 v41, s85, v29
    v_xor_b32 v42, s86, v30
    v_xor_b32 v43, s87, v31
    v_or3_b32 v40, v40, v41, v42
    v_or3_b32 v53, v53, v40, v43
    v_xor_b32 v40, s84, v32
    v_xor_b32 v41, s85, v33
    v_xor_b32 v42, s86, v34
    v_xor_b32 v43, s87, v35
    v_or3_b32 v40, v40, v41, v42
    v_or3_b32 v53, v53, v40, v43
    v_xor_b32 v40, s84, v36
    v_xor_b32 v41, s85, v37
    v_xor_b32 v42, s86, v38
    v_xor_b32 v43, s87, v39
    v_or3_b32 v40, v40, v41, v42
    v_or3_b32 v53, v53, v40, v43
    v_and_b32 v53, 15, v53
    v_cmp_ne_u32 vcc, 0, v53
    s_and_b64 vcc, vcc, exec
    s_cbranch_scc0 L_h_done
    s_add_u32 s78, s78, 1
    s_cmp_lt_u32 s78, 0x200000
    s_cbranch_scc1 L_h_poll
L_h_done:
    v_and_b32 v20, -16, v20
    v_and_b32 v21, -16, v21
    v_and_b32 v22, -16, v22
    v_and_b32 v23, -16, v23
    v_and_b32 v24, -16, v24
    v_and_b32 v25, -16, v25
    v_and_b32 v26, -16, v26
    v_and_b32 v27, -16, v27
    v_and_b32 v28, -16, v28
    v_and_b32 v29, -16, v29
    v_and_b32 v30, -16, v30
    v_and_b32 v31, -16, v31
    v_and_b32 v32, -16, v32
    v_and_b32 v33, -16, v33
    v_and_b32 v34, -16, v34
    v_and_b32 v35, -16, v35
    v_and_b32 v36, -16, v36
    v_and_b32 v37, -16, v37
    v_and_b32 v38, -16, v38
    v_and_b32 v39, -16, v39
    v_add_f32 v20, v20, v24
    v_add_f32 v21, v21, v25
    v_add_f32 v22, v22, v26
    v_add_f32 v23, v23, v27
    v_add_f32 v28, v28, v32
    v_add_f32 v29, v29, v33
    v_add_f32 v30, v30, v34
    v_add_f32 v31, v31, v35
    v_add_f32 v20, v20, v28
    v_add_f32 v21, v21, v29
    v_add_f32 v22, v22, v30
    v_add_f32 v23, v23, v31
    v_mov_b32 v24, v20
    v_mov_b32 v25, v21
    v_mov_b32 v26, v22
    v_mov_b32 v27, v23
    v_permlane32_swap_b32 v20, v24
    v_permlane32_swap_b32 v21, v25
    v_permlane32_swap_b32 v22, v26
    v_permlane32_swap_b32 v23, v27
    v_add_f32 v20, v20, v24
    v_add_f32 v21, v21, v25
    v_add_f32 v22, v22, v26
    v_add_f32 v23, v23, v27
    v_add_f32_dpp v36, v36, v36 row_ror:4 row_mask:0xf bank_mask:0xf
    v_add_f32_dpp v37, v37, v37 row_ror:4 row_mask:0xf bank_mask:0xf
    v_add_f32_dpp v38, v38, v38 row_ror:4 row_mask:0xf bank_mask:0xf
    v_add_f32_dpp v39, v39, v39 row_ror:4 row_mask:0xf bank_mask:0xf
    v_add_f32_dpp v36, v36, v36 row_ror:8 row_mask:0xf bank_mask:0xf
    v_add_f32_dpp v37, v37, v37 row_ror:8 row_mask:0xf bank_mask:0xf
    v_add_f32_dpp v38, v38, v38 row_ror:8 row_mask:0xf bank_mask:0xf
    v_add_f32_dpp v39, v39, v39 row_ror:8 row_mask:0xf bank_mask:0xf
    v_mov_b32 v40, v36
    v_mov_b32 v41, v37
    v_mov_b32 v42, v38
    v_mov_b32 v43, v39
    v_permlane16_swap_b32 v36, v40
    v_permlane16_swap_b32 v37, v41
    v_permlane16_swap_b32 v38, v42
    v_permlane16_swap_b32 v39, v43
    v_add_f32 v36, v36, v40
    v_add_f32 v37, v37, v41
    v_add_f32 v38, v38, v42
    v_add_f32 v39, v39, v43
    s_mov_b32 exec_hi, 0
    ds_write_b128 v6, v[20:23] offset:11264
    s_mov_b32 exec_lo, 15
    ds_write_b128 v6, v[36:39] offset:11776
    s_mov_b64 exec, 0x3ffff
    s_mul_i32 s79, s54, 72
    v_add_u32 v19, s79, v1
    ds_read_b32 v20, v19 offset:11264
    s_waitcnt lgkmcnt(0)
    v_cvt_pk_bf16_f32 v20, v20, v20
    v_and_b32 v20, 0xffff0000, v20
    v_add_f32 v20, v20, v56
    v_cvt_pk_bf16_f32 v20, v20, v20
    v_and_b32 v20, 0xffff0000, v20
    v_mul_f32 v22, v20, v20
    v_mul_f32 v22, v22, v20
    v_mov_b32 v23, v20
    v_fmac_f32 v23, 0x3d372713, v22
    v_mul_f32 v23, 0xc0135761, v23
    v_exp_f32 v23, v23
    s_nop 0
    v_add_f32 v23, 1.0, v23
    v_rcp_f32 v23, v23
    s_nop 0
    v_mul_f32 v20, v20, v23
    v_cvt_pk_bf16_f32 v20, v20, v20
    ds_write_b32 v1, v20 offset:10816
    s_mov_b64 exec, -1
    v_mov_b32 v20, s57
    v_mov_b32 v21, 0
    ds_write_b32 v21, v20 offset:10800
    s_mov_b32 s40, s4
    s_and_b32 s41, s5, 0xffff
    s_mov_b32 s42, 0x480
    s_mov_b32 s43, 0x20000
    s_mov_b32 s44, s22
    s_and_b32 s45, s23, 0xffff
    s_mov_b32 s46, 0x480
    s_mov_b32 s47, 0x20000
    s_min_u32 s58, s68, 64
    s_mul_i32 s58, s58, 32
    v_lshlrev_b32 v19, 3, v0
    s_mov_b64 exec, 15
    buffer_load_dwordx2 v[20:21], v19, s[40:43], s58 offen
    buffer_load_dwordx2 v[22:23], v19, s[44:47], s58 offen
    s_waitcnt vmcnt(0)
    v_lshlrev_b32 v24, 16, v20
    v_and_b32 v25, 0xffff0000, v20
    v_lshlrev_b32 v26, 16, v21
    v_and_b32 v27, 0xffff0000, v21
    v_lshlrev_b32 v28, 16, v22
    v_and_b32 v29, 0xffff0000, v22
    v_lshlrev_b32 v30, 16, v23
    v_and_b32 v31, 0xffff0000, v23
    v_add_f32 v24, v24, v28
    v_add_f32 v25, v25, v29
    v_add_f32 v26, v26, v30
    v_add_f32 v27, v27, v31
    ds_write_b128 v6, v[24:27] offset:12288
    s_mov_b64 exec, -1
    v_mov_b32 v24, 0
    s_and_b32 s59, s56, 7
    s_lshl_b32 s95, s59, 8
    s_add_u32 s95, s95, 0x4000
    s_lshl_b32 s59, s59, 3
    v_mov_b32 v225, s59
    v_and_b32 v220, 3, v0
    v_lshlrev_b32 v220, 8, v220
    v_and_b32 v221, 7, v0
    v_lshlrev_b32 v221, 3, v221
    v_and_b32 v229, 31, v0
    v_lshlrev_b32 v229, 2, v229
    s_lshr_b32 s89, s2, 3
    s_lshl_b32 s59, s89, 2
    v_mov_b32 v224, s59
    v_mov_b32 v228, 0
    s_and_b32 s91, s66, 0xffff0000
    v_mov_b32 v239, s66
    v_mov_b32 v245, s66
    v_mov_b32 v237, -1
    v_mov_b32 v241, 0x41a40000
    s_mov_b32 s59, 0x3f333333
    s_bitcmp1_b32 s56, 0
    s_cselect_b32 s59, 0xbf333333, s59
    v_add_f32 v241, s59, v241
    s_mov_b32 s90, 0x3000
    s_mul_i32 s98, s89, 80
    s_add_u32 s98, s98, 112
    s_cmp_gt_u32 s98, 448
    s_cselect_b32 s98, 0x1000, s98
    s_mov_b32 s99, s98
    v_mov_b32 v242, 0
    v_mov_b32 v243, 0
    v_mov_b32 v244, 0
    s_mov_b32 s101, 1
    s_cmp_eq_u32 s89, 0
    s_cbranch_scc0 L_flow_ready
    s_mov_b64 exec, 1
    buffer_store_dwordx2 v[244:245], v228, s[48:51], s95 offen offset:128
    s_mov_b64 exec, -1
L_flow_ready:
L_max_wait:
    ds_read_b128 v[28:31], v24 offset:10752
    s_waitcnt lgkmcnt(0)
    v_max3_u32 v20, v28, v29, v30
    v_max_u32 v20, v20, v31
    v_cmp_eq_u32 vcc, -1, v20
    s_and_b64 vcc, vcc, exec
    s_cbranch_scc0 L_max_ok
    s_call_b64 s[96:97], L_flow
    s_add_u32 s78, s78, 1
    s_cmp_lt_u32 s78, 0x200000
    s_cbranch_scc1 L_max_wait
L_max_ok:
    v_max3_f32 v32, v28, v29, v30
    v_max_f32 v32, v32, v31
    v_mul_f32_e64 v33, -v32, s65
    v_mov_b32 v34, 0
    v_mov_b32 v25, v6
    s_mov_b32 s39, 0
L_den:
    ds_read_b128 v[36:39], v25 offset:0
    v_add_u32 v25, 1024, v25
    s_waitcnt lgkmcnt(0)
    v_lshlrev_b32 v40, 16, v36
    v_and_b32 v41, 0xffff0000, v36
    v_lshlrev_b32 v42, 16, v37
    v_and_b32 v43, 0xffff0000, v37
    v_lshlrev_b32 v44, 16, v38
    v_and_b32 v45, 0xffff0000, v38
    v_lshlrev_b32 v46, 16, v39
    v_and_b32 v47, 0xffff0000, v39
    v_fma_f32 v40, v40, s65, v33
    v_fma_f32 v41, v41, s65, v33
    v_fma_f32 v42, v42, s65, v33
    v_fma_f32 v43, v43, s65, v33
    v_fma_f32 v44, v44, s65, v33
    v_fma_f32 v45, v45, s65, v33
    v_fma_f32 v46, v46, s65, v33
    v_fma_f32 v47, v47, s65, v33
    v_exp_f32 v40, v40
    v_exp_f32 v41, v41
    v_exp_f32 v42, v42
    v_exp_f32 v43, v43
    v_exp_f32 v44, v44
    v_exp_f32 v45, v45
    v_exp_f32 v46, v46
    v_exp_f32 v47, v47
    s_nop 0
    v_add_f32 v34, v34, v40
    v_add_f32 v34, v34, v41
    v_add_f32 v34, v34, v42
    v_add_f32 v34, v34, v43
    v_add_f32 v34, v34, v44
    v_add_f32 v34, v34, v45
    v_add_f32 v34, v34, v46
    v_add_f32 v34, v34, v47
    s_add_u32 s39, s39, 1
    s_cmp_lt_u32 s39, 8
    s_cbranch_scc1 L_den
    s_nop 1
    v_add_f32_dpp v34, v34, v34 row_ror:8 row_mask:0xf bank_mask:0xf
    s_nop 1
    v_add_f32_dpp v34, v34, v34 row_ror:4 row_mask:0xf bank_mask:0xf
    s_nop 1
    v_add_f32_dpp v34, v34, v34 row_ror:2 row_mask:0xf bank_mask:0xf
    s_nop 1
    v_add_f32_dpp v34, v34, v34 row_ror:1 row_mask:0xf bank_mask:0xf
    v_mov_b32 v20, v34
    s_nop 1
    v_permlane16_swap_b32 v34, v20
    v_add_f32 v34, v34, v20
    v_mov_b32 v20, v34
    s_nop 1
    v_permlane32_swap_b32 v34, v20
    v_add_f32 v34, v34, v20
    v_mov_b32 v33, s66
    v_mov_b32 v35, s67
    s_lshl_b32 s58, s55, 4
    s_add_u32 s58, s58, 0x1000
    s_mov_b64 exec, 1
    s_cmp_eq_u32 s57, 1
    s_cbranch_scc1 L_near70
    buffer_store_dwordx4 v[32:35], v6, s[48:51], s58 offen sc1
    s_branch L_sent70
L_near70:
    buffer_store_dwordx4 v[32:35], v6, s[48:51], s58 offen
L_sent70:
    s_mov_b64 exec, -1
    v_and_b32 v25, 7, v0
    v_lshlrev_b32 v25, 4, v25
    s_lshl_b32 s58, s53, 7
    s_add_u32 s58, s58, 0x1000
L_swait:
    buffer_load_dwordx4 v[40:43], v25, s[48:51], s58 offen sc1
    s_waitcnt vmcnt(0)
    v_xor_b32 v20, s66, v41
    v_xor_b32 v21, s67, v43
    v_or_b32 v20, v20, v21
    v_cmp_ne_u32 vcc, 0, v20
    s_and_b64 vcc, vcc, exec
    s_cbranch_scc0 L_sdone
    s_call_b64 s[96:97], L_flow
    s_add_u32 s78, s78, 1
    s_cmp_lt_u32 s78, 0x200000
    s_cbranch_scc1 L_swait
L_sdone:
    v_and_b32 v25, 3, v0
    v_lshlrev_b32 v25, 2, v25
    ds_read_b32 v45, v25 offset:10752
    v_mov_b32 v44, v40
    s_nop 1
    v_max_f32_dpp v44, v44, v44 row_ror:4 row_mask:0xf bank_mask:0xf
    s_nop 1
    v_max_f32_dpp v44, v44, v44 row_ror:2 row_mask:0xf bank_mask:0xf
    s_nop 1
    v_max_f32_dpp v44, v44, v44 row_ror:1 row_mask:0xf bank_mask:0xf
    v_sub_f32 v40, v40, v44
    v_mul_f32 v40, s65, v40
    v_exp_f32 v40, v40
    s_nop 0
    v_mul_f32 v42, v42, v40
    s_nop 1
    v_add_f32_dpp v42, v42, v42 row_ror:4 row_mask:0xf bank_mask:0xf
    s_nop 1
    v_add_f32_dpp v42, v42, v42 row_ror:2 row_mask:0xf bank_mask:0xf
    s_nop 1
    v_add_f32_dpp v42, v42, v42 row_ror:1 row_mask:0xf bank_mask:0xf
    v_rcp_f32 v42, v42
    s_waitcnt lgkmcnt(0)
    v_sub_f32 v45, v45, v44
    v_mul_f32 v45, s65, v45
    v_exp_f32 v45, v45
    s_nop 0
    v_mul_f32 v45, v45, v42
    s_mov_b64 exec, 15
    ds_write_b32 v25, v45 offset:10784
    s_mov_b64 exec, -1
    v_mov_b32 v20, 10772
    v_mov_b32 v21, 1
    ds_write_b32 v20, v21
    v_lshrrev_b32 v181, 4, v0
    v_mul_u32_u24 v181, 20, v181
    ds_read_b32 v208, v181 offset:10816
    ds_read_b32 v209, v181 offset:10820
    ds_read_b32 v210, v181 offset:10824
    ds_read_b32 v211, v181 offset:10828
    ds_read_b32 v212, v181 offset:10832
    v_and_b32 v182, 15, v0
    v_lshlrev_b32 v182, 6, v182
    v_lshrrev_b32 v183, 4, v0
    v_lshl_add_u32 v182, v183, 4, v182
    s_lshl_b32 s79, s55, 11
    s_add_u32 s79, s79, 0x100000
    v_bfe_u32 v183, v0, 1, 3
    v_lshlrev_b32 v183, 14, v183
    v_and_b32 v184, 1, v0
    v_lshl_add_u32 v183, v184, 5, v183
    v_and_b32 v184, 16, v0
    v_add_u32 v183, v183, v184
    s_lshl_b32 s75, s55, 6
    s_lshl_b32 s59, s52, 17
    s_add_u32 s75, s75, s59
    s_add_u32 s75, s75, 0x60000
L_fc:
    s_call_b64 s[96:97], L_flow
    s_cmp_ge_u32 s92, 496
    s_cbranch_scc1 L_fc_end
    s_add_u32 s78, s78, 1
    s_cmp_lt_u32 s78, 0x200000
    s_cbranch_scc1 L_fc
L_fc_end:
    v_mov_b32 v222, 512
    v_mov_b32 v226, 24
    v_or_b32 v223, s91, v222
    s_mov_b64 exec, 1
    buffer_store_dword v223, v224, s[48:51], s95 offen
    s_mov_b64 exec, -1
    s_mov_b64 exec, 15
    ds_write_b32 v1, v226 offset:13312
    s_mov_b64 exec, -1
    v_lshrrev_b32 v186, 4, v0
    v_and_b32 v187, 15, v0
    v_lshlrev_b32 v187, 4, v187
    v_mul_u32_u24 v185, 4608, v186
    v_add_u32 v185, v185, v187
    v_mul_u32_u24 v186, 5760, v186
    v_add_u32 v186, v186, v187
    s_lshl_b32 s59, s52, 8
    s_mul_i32 s93, s55, 18432
    s_add_u32 s93, s93, s59
    s_mul_i32 s94, s55, 20736
    s_add_u32 s94, s94, s59
    s_add_u32 s95, s94, 4608
    s_mov_b32 s40, s20
    s_and_b32 s41, s21, 0xffff
    s_mov_b32 s42, 0x510000
    s_mov_b32 s43, 0x20000
    s_mov_b32 s44, s12
    s_and_b32 s45, s13, 0xffff
    s_mov_b32 s46, 0x480000
    s_mov_b32 s47, 0x20000
L_issued:
    ds_read_b32 v222, v220 offset:14336
    s_waitcnt lgkmcnt(0)
    v_lshlrev_b32 v236, 2, v222
    v_add_u32_dpp v222, v222, v222 quad_perm:[1,0,3,2] row_mask:0xf bank_mask:0xf
    s_nop 1
    v_add_u32_dpp v222, v222, v222 quad_perm:[2,3,0,1] row_mask:0xf bank_mask:0xf
    s_nop 1
    v_readfirstlane_b32 s92, v222
    s_cmp_ge_u32 s92, 512
    s_cbranch_scc1 L_issued_ok
    s_sleep 2
    s_add_u32 s78, s78, 1
    s_cmp_lt_u32 s78, 0x200000
    s_cbranch_scc1 L_issued
L_issued_ok:
    s_mov_b32 exec_lo, 0xff00ff
    s_mov_b32 exec_hi, 0xff00ff
    buffer_load_dwordx4 v[188:191], v186, s[40:43], s94 offen offset:0 nt
    buffer_load_dwordx4 v[192:195], v186, s[40:43], s94 offen offset:1152 nt
    buffer_load_dwordx4 v[196:199], v186, s[40:43], s94 offen offset:2304 nt
    buffer_load_dwordx4 v[200:203], v186, s[40:43], s94 offen offset:3456 nt
    buffer_load_dwordx4 v[204:207], v186, s[40:43], s95 offen offset:0 nt
    buffer_load_dwordx4 v[160:163], v185, s[44:47], s93 offen offset:0 nt
    buffer_load_dwordx4 v[164:167], v185, s[44:47], s93 offen offset:1152 nt
    buffer_load_dwordx4 v[168:171], v185, s[44:47], s93 offen offset:2304 nt
    buffer_load_dwordx4 v[172:175], v185, s[44:47], s93 offen offset:3456 nt
    s_mov_b64 exec, -1
    s_waitcnt vmcnt(4)
    v_and_b32 v68, v208, v2
    v_and_b32 v69, v208, v3
    v_and_b32 v70, v208, v4
    v_and_b32 v71, v208, v5
    v_and_b32 v72, v209, v2
    v_and_b32 v73, v209, v3
    v_and_b32 v74, v209, v4
    v_and_b32 v75, v209, v5
    v_mfma_f32_16x16x32_bf16 v[176:179], v[68:71], v[188:191], 0
    v_and_b32 v68, v210, v2
    v_and_b32 v69, v210, v3
    v_and_b32 v70, v210, v4
    v_and_b32 v71, v210, v5
    v_mfma_f32_16x16x32_bf16 v[176:179], v[72:75], v[192:195], v[176:179]
    v_and_b32 v72, v211, v2
    v_and_b32 v73, v211, v3
    v_and_b32 v74, v211, v4
    v_and_b32 v75, v211, v5
    v_mfma_f32_16x16x32_bf16 v[176:179], v[68:71], v[196:199], v[176:179]
    v_and_b32 v68, v212, v2
    v_and_b32 v69, v212, v3
    v_and_b32 v70, v212, v4
    v_and_b32 v71, v212, v5
    v_mfma_f32_16x16x32_bf16 v[176:179], v[72:75], v[200:203], v[176:179]
    s_nop 0
    v_mfma_f32_16x16x32_bf16 v[176:179], v[68:71], v[204:207], v[176:179]
    v_mov_b32 v20, 10776
L_last_wait:
    ds_read_b32 v21, v20
    s_waitcnt lgkmcnt(0)
    v_readfirstlane_b32 s58, v21
    s_cmp_eq_u32 s58, 4
    s_cbranch_scc1 L_last_ok
    s_sleep 1
    s_add_u32 s78, s78, 1
    s_cmp_lt_u32 s78, 0x200000
    s_cbranch_scc1 L_last_wait
L_last_ok:
L_h_owait:
    buffer_load_dwordx4 v[60:63], v182, s[48:51], s79 offen sc1
    buffer_load_dwordx4 v[64:67], v182, s[48:51], s79 offen offset:1024 sc1
    s_waitcnt vmcnt(0)
    v_xor_b32 v68, s84, v60
    v_xor_b32 v69, s85, v61
    v_xor_b32 v70, s86, v62
    v_xor_b32 v71, s87, v63
    v_or3_b32 v68, v68, v69, v70
    v_or_b32 v20, v68, v71
    v_xor_b32 v68, s84, v64
    v_xor_b32 v69, s85, v65
    v_xor_b32 v70, s86, v66
    v_xor_b32 v71, s87, v67
    v_or3_b32 v68, v68, v69, v70
    v_or3_b32 v20, v20, v68, v71
    v_and_b32 v20, 15, v20
    v_cmp_ne_u32 vcc, 0, v20
    s_or_b32 vcc_lo, vcc_lo, vcc_hi
    s_lshr_b32 s58, vcc_lo, 16
    s_or_b32 s58, s58, vcc_lo
    s_and_b32 s58, s58, 0xffff
    s_cbranch_scc0 L_h_odone
    s_mul_i32 exec_lo, s58, 0x10001
    s_mov_b32 exec_hi, exec_lo
    s_add_u32 s78, s78, 1
    s_cmp_lt_u32 s78, 0x200000
    s_cbranch_scc1 L_h_owait
L_h_odone:
    s_mov_b64 exec, -1
    v_and_b32 v60, -16, v60
    v_and_b32 v61, -16, v61
    v_and_b32 v62, -16, v62
    v_and_b32 v63, -16, v63
    v_and_b32 v64, -16, v64
    v_and_b32 v65, -16, v65
    v_and_b32 v66, -16, v66
    v_and_b32 v67, -16, v67
    v_add_f32 v60, v60, v64
    v_add_f32 v61, v61, v65
    v_add_f32 v62, v62, v66
    v_add_f32 v63, v63, v67
    v_add_f32_dpp v60, v60, v60 row_ror:8 row_mask:0xf bank_mask:0xf
    v_add_f32_dpp v61, v61, v61 row_ror:8 row_mask:0xf bank_mask:0xf
    v_add_f32_dpp v62, v62, v62 row_ror:8 row_mask:0xf bank_mask:0xf
    v_add_f32_dpp v63, v63, v63 row_ror:8 row_mask:0xf bank_mask:0xf
    v_add_f32_dpp v60, v60, v60 row_ror:4 row_mask:0xf bank_mask:0xf
    v_add_f32_dpp v61, v61, v61 row_ror:4 row_mask:0xf bank_mask:0xf
    v_add_f32_dpp v62, v62, v62 row_ror:4 row_mask:0xf bank_mask:0xf
    v_add_f32_dpp v63, v63, v63 row_ror:4 row_mask:0xf bank_mask:0xf
    v_add_f32_dpp v60, v60, v60 row_ror:2 row_mask:0xf bank_mask:0xf
    v_add_f32_dpp v61, v61, v61 row_ror:2 row_mask:0xf bank_mask:0xf
    v_add_f32_dpp v62, v62, v62 row_ror:2 row_mask:0xf bank_mask:0xf
    v_add_f32_dpp v63, v63, v63 row_ror:2 row_mask:0xf bank_mask:0xf
    v_add_f32_dpp v60, v60, v60 row_ror:1 row_mask:0xf bank_mask:0xf
    v_add_f32_dpp v61, v61, v61 row_ror:1 row_mask:0xf bank_mask:0xf
    v_add_f32_dpp v62, v62, v62 row_ror:1 row_mask:0xf bank_mask:0xf
    v_add_f32_dpp v63, v63, v63 row_ror:1 row_mask:0xf bank_mask:0xf
    v_cvt_pk_bf16_f32 v60, v60, v60
    v_cvt_pk_bf16_f32 v61, v61, v61
    v_cvt_pk_bf16_f32 v62, v62, v62
    v_cvt_pk_bf16_f32 v63, v63, v63
    v_and_b32 v68, v60, v2
    v_and_b32 v69, v60, v3
    v_and_b32 v70, v60, v4
    v_and_b32 v71, v60, v5
    v_and_b32 v72, v61, v2
    v_and_b32 v73, v61, v3
    v_and_b32 v74, v61, v4
    v_and_b32 v75, v61, v5
    v_mfma_f32_16x16x32_bf16 v[176:179], v[68:71], v[160:163], v[176:179]
    v_and_b32 v76, v62, v2
    v_and_b32 v77, v62, v3
    v_and_b32 v78, v62, v4
    v_and_b32 v79, v62, v5
    v_mfma_f32_16x16x32_bf16 v[176:179], v[72:75], v[164:167], v[176:179]
    v_and_b32 v80, v63, v2
    v_and_b32 v81, v63, v3
    v_and_b32 v82, v63, v4
    v_and_b32 v83, v63, v5
    v_mfma_f32_16x16x32_bf16 v[176:179], v[76:79], v[168:171], v[176:179]
    s_nop 1
    v_mfma_f32_16x16x32_bf16 v[176:179], v[80:83], v[172:175], v[176:179]
    s_mov_b32 exec_lo, 0xff00ff
    s_mov_b32 exec_hi, 0x0
    s_nop 5
    v_bfi_b32 v176, 15, s84, v176
    v_bfi_b32 v177, 15, s85, v177
    v_bfi_b32 v178, 15, s86, v178
    v_bfi_b32 v179, 15, s87, v179
    buffer_store_dwordx4 v[176:179], v183, s[48:51], s75 offen sc1
    s_mov_b64 exec, -1
    s_endpgm
L_flow:
    ds_read_b32 v222, v220 offset:14336
    s_waitcnt lgkmcnt(0)
    v_lshlrev_b32 v236, 2, v222
    v_add_u32_dpp v222, v222, v222 quad_perm:[1,0,3,2] row_mask:0xf bank_mask:0xf
    s_nop 1
    v_add_u32_dpp v222, v222, v222 quad_perm:[2,3,0,1] row_mask:0xf bank_mask:0xf
    s_nop 1
    v_readfirstlane_b32 s92, v222
    v_or_b32 v223, s91, v222
    s_mov_b64 exec, 1
    buffer_store_dword v223, v224, s[48:51], s95 offen
    s_mov_b64 exec, -1
    buffer_load_dword v230, v229, s[48:51], s95 offen sc1
    buffer_load_dwordx2 v[232:233], v228, s[48:51], s95 offen offset:128 sc1
    s_cmp_eq_u32 s101, 0
    s_cbranch_scc0 L_flow_local
    buffer_load_dwordx2 v[226:227], v221, s[48:51], s90 offen sc1
L_flow_local:
    v_cmp_gt_i32 vcc, 0, v237
    s_nop 1
    v_cndmask_b32 v237, v237, v236, vcc
    v_add_u32 v237, v237, v236
    s_waitcnt vmcnt(0)
    v_xor_b32 v234, s91, v230
    v_cmp_gt_u32 vcc, 0x10000, v234
    v_or_b32 v234, 0x100000, v234
    s_nop 0
    v_cndmask_b32 v234, 0, v234, vcc
    s_nop 1
    v_add_u32_dpp v234, v234, v234 row_ror:8 row_mask:0xf bank_mask:0xf
    s_nop 1
    v_add_u32_dpp v234, v234, v234 row_ror:4 row_mask:0xf bank_mask:0xf
    s_nop 1
    v_add_u32_dpp v234, v234, v234 row_ror:2 row_mask:0xf bank_mask:0xf
    s_nop 1
    v_add_u32_dpp v234, v234, v234 row_ror:1 row_mask:0xf bank_mask:0xf
    v_mov_b32 v235, v234
    s_nop 1
    v_permlane16_swap_b32 v234, v235
    v_add_u32 v234, v234, v235
    v_lshrrev_b32 v235, 20, v234
    v_and_b32 v234, 0xfffff, v234
    v_cvt_f32_u32 v235, v235
    v_cvt_f32_u32 v234, v234
    v_rcp_f32 v235, v235
    v_cmp_eq_u32 vcc, s66, v233
    v_mul_f32 v238, v234, v235
    v_cvt_f32_u32 v235, v237
    v_fma_f32 v234, v235, -0.5, v238
    v_mul_f32 v234, 0x3f800000, v234
    v_add_f32 v234, v234, v241
    v_cndmask_b32 v232, 0, v232, vcc
    v_add_f32 v234, v234, v232
    v_cvt_i32_f32 v234, v234
    v_cvt_u32_f32 v235, v238
    s_mov_b64 exec, 15
    ds_write_b32 v1, v234 offset:13312
    s_mov_b64 exec, -1
    v_mov_b32 v237, v236
    v_readfirstlane_b32 s100, v235
    s_sub_u32 s59, s100, s98
    s_cmp_eq_u32 s101, 0
    s_cbranch_scc1 L_flow_watch
    s_cmp_ge_i32 s59, -32
    s_cselect_b32 s101, 0, 1
    s_branch L_flow_done
L_flow_watch:
    s_cmp_ge_u32 s100, s99
    s_cbranch_scc0 L_flow_seen
    v_mov_b32 v238, s100
    s_mov_b32 s99, -1
    s_mov_b64 exec, 1
    buffer_store_dwordx2 v[238:239], v225, s[48:51], s90 offen sc1
    s_mov_b64 exec, -1
L_flow_seen:
    v_cmp_eq_u32 vcc, s66, v227
    v_cmp_le_u32 s[70:71], s98, v226
    s_and_b64 vcc, vcc, s[70:71]
    v_cmp_eq_f32 s[70:71], 0, v243
    s_and_b64 vcc, vcc, s[70:71]
    v_sub_u32 v235, s100, v226
    v_cvt_f32_i32 v235, v235
    v_cndmask_b32 v242, v242, v235, vcc
    v_cndmask_b32 v243, v243, 1.0, vcc
    v_cmp_eq_f32 vcc, 0, v243
    s_and_b64 vcc, vcc, exec
    s_cbranch_scc0 L_flow_round
    s_cmp_ge_i32 s59, 48
    s_cbranch_scc0 L_flow_done
L_flow_round:
    v_add_f32_dpp v242, v242, v242 row_ror:4 row_mask:0xf bank_mask:0xf
    v_add_f32_dpp v243, v243, v243 row_ror:4 row_mask:0xf bank_mask:0xf
    s_nop 0
    v_add_f32_dpp v242, v242, v242 row_ror:2 row_mask:0xf bank_mask:0xf
    v_add_f32_dpp v243, v243, v243 row_ror:2 row_mask:0xf bank_mask:0xf
    s_nop 0
    v_add_f32_dpp v242, v242, v242 row_ror:1 row_mask:0xf bank_mask:0xf
    v_add_f32_dpp v243, v243, v243 row_ror:1 row_mask:0xf bank_mask:0xf
    s_nop 0
    v_max_f32 v243, 1.0, v243
    v_rcp_f32 v243, v243
    v_mov_b32 v244, 0x41100000
    v_fma_f32 v244, -v242, v243, v244
    v_mul_f32 v244, 0x3f4ccccd, v244
    s_mov_b64 exec, 1
    buffer_store_dwordx2 v[244:245], v228, s[48:51], s95 offen offset:128
    s_mov_b64 exec, -1
    s_mov_b32 s98, 0x1000
    s_mov_b32 s101, 1
L_flow_done:
    s_cmp_eq_u32 s101, 0
    s_cbranch_scc1 L_flow_exit
    s_sleep 8
L_flow_exit:
    s_setpc_b64 s[96:97]
L_exit:
    s_endpgm
.section .rodata,"a"
.p2align 6
.amdhsa_kernel parallel_sum__mha_block_cached__dense_activation_gelu__decode_kernel
  .amdhsa_next_free_vgpr 256
  .amdhsa_next_free_sgpr 102
  .amdhsa_accum_offset 256
  .amdhsa_group_segment_fixed_size 0
  .amdhsa_kernarg_size 104
  .amdhsa_user_sgpr_count 2
  .amdhsa_user_sgpr_kernarg_segment_ptr 1
  .amdhsa_system_sgpr_workgroup_id_x 1
  .amdhsa_float_denorm_mode_32 3
.end_amdhsa_kernel
```
